```python
import torch

def _softmax(x, axis=-1):
    return torch.softmax(x, dim=axis)
def _gelu(x):
    return torch.nn.functional.gelu(x, approximate="tanh")
def _silu(x):
    return torch.nn.functional.silu(x)
def _sigmoid(x):
    return torch.sigmoid(x)
def _layernorm(x, axis=-1, eps=1e-5):
    m = x.mean(dim=axis, keepdim=True)
    v = x.var(dim=axis, keepdim=True, unbiased=False)
    return (x - m) / torch.sqrt(v + eps)
def _scatter_add(tgt, idx, src, axis=0):
    return tgt.clone().index_add_(axis, idx, src)
def _segment_sum(src, seg, n):
    out = torch.zeros((n,) + src.shape[1:], dtype=src.dtype)
    return out.index_add_(0, seg, src)
def _pad(x, pw):
    flat = tuple(v for pair in reversed(pw) for v in pair)
    return torch.nn.functional.pad(x, flat)

kernel_name = 'recurrent_scan__spectral_fnet__glu_gated_geglu__prompt'

def setup_inputs():

    _w = (lambda a: (lambda t: t.to(torch.bfloat16) if t.is_floating_point() else t)(torch.as_tensor(a)))
    def _A_setup():
        B, S, D = 1, 2048, 512
        ns = torch.arange(S)[:, None] * torch.arange(S)[None, :]
        nd = torch.arange(D)[:, None] * torch.arange(D)[None, :]
        Ws_re = torch.cos(-2.0 * torch.pi * ns / S).to(float)
        Ws_im = torch.sin(-2.0 * torch.pi * ns / S).to(float)
        Wd_re = torch.cos(-2.0 * torch.pi * nd / D).to(float)
        Wd_im = torch.sin(-2.0 * torch.pi * nd / D).to(float)
        return {
            "x": _w((lambda *s: torch.randn(*s, dtype=torch.bfloat16) * 0.05)(B, S, D)),
            "dft_seq_re": _w(Ws_re),
            "dft_seq_im": _w(Ws_im),
            "dft_hid_re": _w(Wd_re),
            "dft_hid_im": _w(Wd_im),
        }
    _A_in = _A_setup()

    def _B_setup():
        B, S, Dm, Df = 1, 2048, 512, 1376
        return {
            "x": _w((lambda *s: torch.randn(*s, dtype=torch.bfloat16) * 0.05)(B, S, Dm)),
            "w_gate": _w((lambda *s: torch.randn(*s, dtype=torch.bfloat16) * 0.05)(Dm, Df) * (Dm ** -0.5)),
            "w_up": _w((lambda *s: torch.randn(*s, dtype=torch.bfloat16) * 0.05)(Dm, Df) * (Dm ** -0.5)),
            "w_down": _w((lambda *s: torch.randn(*s, dtype=torch.bfloat16) * 0.05)(Df, Dm) * (Df ** -0.5)),
        }
    _B_in = _B_setup()

    return {
        "A_x": _A_in["x"],
        "A_dft_seq_re": _A_in["dft_seq_re"],
        "A_dft_seq_im": _A_in["dft_seq_im"],
        "A_dft_hid_re": _A_in["dft_hid_re"],
        "A_dft_hid_im": _A_in["dft_hid_im"],
        "B_x": _B_in["x"],
        "B_w_gate": _B_in["w_gate"],
        "B_w_up": _B_in["w_up"],
        "B_w_down": _B_in["w_down"],
    }

def reference(A_x, A_dft_seq_re, A_dft_seq_im, A_dft_hid_re, A_dft_hid_im, B_x, B_w_gate, B_w_up, B_w_down):
    def _A_ref(x, dft_seq_re, dft_seq_im, dft_hid_re, dft_hid_im):
        a = torch.einsum("bsd,ed->bse", x, dft_hid_re)
        b = torch.einsum("bsd,ed->bse", x, dft_hid_im)
        y = torch.einsum("ts,bse->bte", dft_seq_re, a) - torch.einsum("ts,bse->bte", dft_seq_im, b)
        return y

    def _B_ref(x, w_gate, w_up, w_down):
        g = torch.einsum("bsd,df->bsf", x, w_gate)
        u = torch.einsum("bsd,df->bsf", x, w_up)
        h = _gelu(g) * u
        return torch.einsum("bsf,fd->bsd", h, w_down)

    x = A_x
    xn = _layernorm(x, axis=-1)
    s = _A_ref(xn, A_dft_seq_re, A_dft_seq_im, A_dft_hid_re, A_dft_hid_im)
    g = _silu(_B_ref(xn, B_w_gate, B_w_up, B_w_down))
    return x + s * g
```

```asm
; @launch grid=(256,1,1) block=(512,1,1) lds=163840
.amdgcn_target "amdgcn-amd-amdhsa--gfx950"
.text
.globl recurrent_scan__spectral_fnet__glu_gated_geglu__prompt_kernel
.p2align 8
.type recurrent_scan__spectral_fnet__glu_gated_geglu__prompt_kernel,@function
recurrent_scan__spectral_fnet__glu_gated_geglu__prompt_kernel:
    s_cmp_ge_u32 s2, 256
    s_cbranch_scc1 K_end
    s_load_dwordx2 s[12:13], s[0:1], 0
    s_load_dwordx4 s[56:59], s[0:1], 48
    s_load_dwordx2 s[64:65], s[0:1], 64
    s_load_dwordx2 s[68:69], s[0:1], 72
    s_load_dwordx2 s[62:63], s[0:1], 80
    s_load_dwordx2 s[10:11], s[0:1], 88
    v_lshrrev_b32 v1, 6, v0
    v_and_b32 v230, 63, v0
    v_readfirstlane_b32 s3, v1
    s_getpc_b64 s[96:97]
L_pc:
    s_cmp_lt_u32 s3, 4
    s_cbranch_scc1 L_nopf
    s_lshr_b32 s98, s2, 3
    s_lshl_b32 s98, s98, 2
    s_add_u32 s98, s98, s3
    s_lshl_b32 s98, s98, 6
    s_add_u32 s99, s98, 8192
    s_min_u32 s99, s99, PF_end-L_pc-4
    s_load_dword s100, s[96:97], s99
    s_add_u32 s99, s98, 16384
    s_min_u32 s99, s99, PF_end-L_pc-4
    s_load_dword s101, s[96:97], s99
    s_add_u32 s99, s98, 24576
    s_min_u32 s99, s99, PF_end-L_pc-4
    s_load_dword s100, s[96:97], s99
    s_add_u32 s99, s98, 0
    s_min_u32 s99, s99, PF_end-L_pc-4
    s_load_dword s101, s[96:97], s99
L_nopf:
    s_and_b32 s28, s2, 7
    s_lshr_b32 s29, s2, 3
    s_lshr_b32 s6, s28, 2
    s_lshl_b32 s6, s6, 3
    s_and_b32 s30, s29, 7
    s_add_u32 s6, s6, s30
    s_and_b32 s7, s28, 3
    s_lshl_b32 s7, s7, 2
    s_lshr_b32 s31, s29, 3
    s_add_u32 s7, s7, s31
    s_lshl_b32 s8, s31, 1
    s_add_u32 s8, s8, s30
    s_and_b32 s31, s28, 1
    s_add_u32 s8, s8, s31
    s_and_b32 s4, s3, 3
    s_mov_b32 s14, 0x200000
    s_mov_b32 s15, 0x20000
    s_mov_b32 s72, 0x1b6db688
    s_mov_b32 s73, 0xdb6b
    s_mul_i32 s30, s7, 3
    s_lshr_b64 s[72:73], s[72:73], s30
    s_and_b32 s72, s72, 7
    s_mul_i32 s24, s7, 5
    s_add_u32 s24, s24, s72
    s_lshr_b32 s25, 0xe07, s7
    s_and_b32 s25, s25, 1
    s_mov_b32 s32, 0xffff0000
    s_and_b32 s73, s28, 4
    s_lshl_b32 s73, s73, 4
    s_cmp_lt_u32 s3, 4
    s_cbranch_scc1 K_h
    s_branch K_c
K_h:
    s_setprio 3
    s_lshr_b32 s75, s7, 2
    s_and_b32 s75, s75, 2
    s_lshl_b32 s51, s6, 1
    s_and_b32 s77, s4, 1
    s_add_u32 s28, s51, s77
    s_lshr_b32 s33, s4, 1
    s_lshl_b32 s31, s33, 5
    s_add_u32 s28, s28, s31
    s_lshl_b32 s28, s28, 10
    s_lshl_b32 s29, s4, 12
    s_lshl_b32 s31, s75, 19
    s_add_u32 s28, s28, s31
    s_xor_b32 s34, s28, 0x100000
    s_lshl_b32 s31, s75, 10
    s_add_u32 s74, s29, s31
    s_xor_b32 s55, s74, 0x800
    v_lshrrev_b32 v240, 3, v230
    v_lshrrev_b32 v241, 1, v240
    v_and_b32 v242, 7, v230
    v_xor_b32 v241, v241, v242
    v_lshlrev_b32 v241, 4, v241
    v_lshl_add_u32 v224, v240, 16, v241
    v_xor_b32 v225, 64, v224
    s_waitcnt lgkmcnt(0)
    s_and_b32 s13, s13, 0xffff
    s_add_u32 s30, s8, 0
    s_and_b32 s30, s30, 7
    s_lshl_b32 s30, s30, 7
    s_add_u32 s30, s30, s28
    s_add_u32 m0, s74, 0
    s_nop 0
    buffer_load_dwordx4 v224, s[12:15], s30 offen lds
    s_add_u32 m0, s74, 1024
    s_add_u32 s30, s30, 0x80000
    buffer_load_dwordx4 v225, s[12:15], s30 offen lds
    s_add_u32 s30, s8, 0
    s_and_b32 s30, s30, 7
    s_lshl_b32 s30, s30, 7
    s_add_u32 s30, s30, s34
    s_add_u32 m0, s55, 0
    s_nop 0
    buffer_load_dwordx4 v224, s[12:15], s30 offen lds
    s_add_u32 m0, s55, 1024
    s_add_u32 s30, s30, 0x80000
    buffer_load_dwordx4 v225, s[12:15], s30 offen lds
    s_cmp_eq_u32 s77, 0
    s_cselect_b32 s16, s56, s58
    s_cselect_b32 s17, s57, s59
    s_and_b32 s17, s17, 0xffff
    s_mov_b32 s18, 1409024
    s_mov_b32 s19, 0x20000
    s_mul_i32 s26, s33, 44032
    s_lshl_b32 s31, s24, 5
    s_add_u32 s26, s26, s31
    s_mul_i32 s31, s73, 1376
    s_sub_u32 s9, s26, s31
    s_add_u32 s9, s9, 88064
    s_add_u32 s26, s26, s31
    s_mul_i32 s27, s77, 6176
    s_mul_i32 s31, s33, 3072
    s_add_u32 s27, s27, s31
    s_lshl_b32 s35, s25, 1
    s_add_u32 s35, s35, 10
    v_mov_b32 v243, 0x40000000
    v_add_u32 v240, 0, v230
    v_mul_u32_u24 v241, 5462, v240
    v_lshrrev_b32 v241, 16, v241
    v_mul_u32_u24 v242, 12, v241
    v_sub_u32 v242, v240, v242
    v_cmp_le_u32 vcc, s35, v242
    v_mul_u32_u24 v241, 2752, v241
    v_lshl_add_u32 v231, v242, 4, v241
    v_cndmask_b32 v231, v231, v243, vcc
    v_add_u32 v240, 64, v230
    v_mul_u32_u24 v241, 5462, v240
    v_lshrrev_b32 v241, 16, v241
    v_mul_u32_u24 v242, 12, v241
    v_sub_u32 v242, v240, v242
    v_cmp_le_u32 vcc, s35, v242
    v_mul_u32_u24 v241, 2752, v241
    v_lshl_add_u32 v232, v242, 4, v241
    v_cndmask_b32 v232, v232, v243, vcc
    v_add_u32 v240, 128, v230
    v_mul_u32_u24 v241, 5462, v240
    v_lshrrev_b32 v241, 16, v241
    v_mul_u32_u24 v242, 12, v241
    v_sub_u32 v242, v240, v242
    v_cmp_le_u32 vcc, s35, v242
    v_mul_u32_u24 v241, 2752, v241
    v_lshl_add_u32 v233, v242, 4, v241
    v_cndmask_b32 v233, v233, v243, vcc
    s_add_u32 s31, s8, 0
    s_and_b32 s31, s31, 7
    s_mul_i32 s31, s31, 176128
    s_add_u32 s31, s31, s26
    s_add_u32 m0, s27, 49152
    s_nop 0
    buffer_load_dwordx4 v231, s[16:19], s31 offen lds
    s_add_u32 m0, s27, 50176
    s_nop 0
    buffer_load_dwordx4 v232, s[16:19], s31 offen lds
    s_add_u32 m0, s27, 51200
    s_nop 0
    buffer_load_dwordx4 v233, s[16:19], s31 offen lds
    s_add_u32 s31, s8, 0
    s_and_b32 s31, s31, 7
    s_mul_i32 s31, s31, 176128
    s_add_u32 s31, s31, s9
    s_add_u32 m0, s27, 61504
    s_nop 0
    buffer_load_dwordx4 v231, s[16:19], s31 offen lds
    s_add_u32 m0, s27, 62528
    s_nop 0
    buffer_load_dwordx4 v232, s[16:19], s31 offen lds
    s_add_u32 m0, s27, 63552
    s_nop 0
    buffer_load_dwordx4 v233, s[16:19], s31 offen lds
    s_add_u32 s30, s8, 1
    s_and_b32 s30, s30, 7
    s_lshl_b32 s30, s30, 7
    s_add_u32 s30, s30, s28
    s_add_u32 m0, s74, 16384
    s_nop 0
    buffer_load_dwordx4 v224, s[12:15], s30 offen lds
    s_add_u32 m0, s74, 17408
    s_add_u32 s30, s30, 0x80000
    buffer_load_dwordx4 v225, s[12:15], s30 offen lds
    s_add_u32 s30, s8, 1
    s_and_b32 s30, s30, 7
    s_lshl_b32 s30, s30, 7
    s_add_u32 s30, s30, s34
    s_add_u32 m0, s55, 16384
    s_nop 0
    buffer_load_dwordx4 v224, s[12:15], s30 offen lds
    s_add_u32 m0, s55, 17408
    s_add_u32 s30, s30, 0x80000
    buffer_load_dwordx4 v225, s[12:15], s30 offen lds
    v_and_b32 v240, 31, v230
    v_lshrrev_b32 v241, 5, v230
    v_bfe_u32 v242, v230, 1, 3
    v_xor_b32 v241, v241, v242
    v_lshlrev_b32 v241, 4, v241
    v_lshl_add_u32 v240, v240, 7, s29
    v_xor_b32 v242, 0, v241
    v_add_u32 v226, v240, v242
    v_xor_b32 v242, 32, v241
    v_add_u32 v227, v240, v242
    v_xor_b32 v242, 64, v241
    v_add_u32 v228, v240, v242
    v_xor_b32 v242, 96, v241
    v_add_u32 v229, v240, v242
    s_add_u32 s68, s10, 6291456
    s_addc_u32 s69, s11, 0
    s_and_b32 s69, s69, 0xffff
    s_mov_b32 s70, 2162688
    s_mov_b32 s71, 0x20000
    s_lshl_b32 s50, s4, 7
    s_add_u32 s50, s50, s6
    s_lshl_b32 s50, s50, 4
    s_add_u32 s50, s50, s7
    s_lshl_b32 s50, s50, 8
    s_add_u32 s35, s50, 0x40000
    s_lshl_b32 s48, s4, 7
    s_add_u32 s48, s48, 160256
    s_lshl_b32 s49, s4, 9
    s_add_u32 s49, s49, 152064
    s_lshl_b32 s38, s6, 11
    s_lshl_b32 s78, s4, 9
    s_add_u32 s38, s38, s78
    s_add_u32 s38, s38, 9437184
    s_lshl_b32 s36, s7, 4
    s_add_u32 s36, s36, s6
    s_lshl_b32 s36, s36, 7
    s_add_u32 s36, s36, 8781824
    s_and_b32 s78, s2, 7
    s_lshr_b32 s79, s2, 3
    s_and_b32 s77, s79, 3
    s_lshl_b32 s56, s78, 2
    s_add_u32 s56, s56, s77
    s_lshr_b32 s57, s79, 2
    s_lshl_b32 s77, s77, 1
    s_add_u32 s77, s77, s57
    s_and_b32 s77, s77, 7
    s_lshl_b32 s72, s77, 2
    s_mul_i32 s73, s77, 11
    s_lshr_b32 s73, s73, 3
    s_lshr_b32 s58, s4, 1
    s_mul_i32 s58, s58, 43
    s_and_b32 s65, s65, 0xffff
    s_mov_b32 s66, 1409024
    s_mov_b32 s67, 0x20000
    s_cmp_lt_u32 s4, 2
    s_cselect_b32 s54, 0xa9876420, 0
    s_cselect_b32 s46, 0xd4941882, 0
    s_cselect_b32 s47, 0x456562, 0
    s_cselect_b32 s54, s54, 0xa9875310
    s_cselect_b32 s46, s46, 0xd4939462
    s_cselect_b32 s47, s47, 0x5a0a62
    s_lshl_b32 s52, s58, 14
    s_lshl_b32 s79, s57, 7
    s_add_u32 s52, s52, s79
    s_and_b32 s79, s4, 1
    s_lshl_b32 s79, s79, 13
    s_add_u32 s52, s52, s79
    s_lshl_b32 s53, s4, 10
    v_lshrrev_b32 v240, 3, v230
    v_bfe_u32 v241, v230, 4, 1
    v_lshlrev_b32 v241, 2, v241
    v_and_b32 v242, 7, v230
    v_xor_b32 v241, v241, v242
    v_lshlrev_b32 v241, 4, v241
    v_lshl_add_u32 v234, v240, 10, v241
    s_and_b32 s78, s4, 1
    s_lshl_b32 s78, s78, 5
    s_add_u32 s51, s56, s78
    s_lshl_b32 s20, s57, 6
    s_lshl_b32 s78, s33, 5
    s_add_u32 s20, s20, s78
    s_sub_u32 s79, 511, s20
    s_sub_u32 s21, s20, 1
    s_sub_u32 s22, 32, s56
    s_and_b32 s22, s22, 31
    s_lshl_b32 s78, s57, 2
    s_max_u32 s23, s78, 1
    s_sub_u32 s23, s23, 1
    s_sub_u32 s78, 28, s78
    s_min_u32 s78, s78, 11
    s_cmp_lt_u32 s57, 4
    s_cselect_b32 s59, 1, -1
    s_cselect_b32 s21, s21, s79
    s_cselect_b32 s22, s56, s22
    s_cselect_b32 s23, s23, s78
    s_lshl_b32 s33, s22, 16
    s_lshl_b32 s39, s23, 11
    s_add_u32 s39, s39, 8781824
    s_lshl_b32 s77, s4, 2
    v_and_b32 v240, 31, v230
    v_lshl_add_u32 v248, v240, 4, s38
    s_lshl_b32 s78, s4, 9
    s_add_u32 s78, s78, 161280
    v_lshl_add_u32 v238, v240, 4, s78
    v_lshrrev_b32 v239, 5, v230
    v_lshlrev_b32 v239, 10, v239
    v_lshl_add_u32 v239, v230, 4, v239
    s_add_u32 s78, s77, 148480
    v_add_u32 v239, s78, v239
    s_add_u32 s78, s77, 160944
    v_mov_b32 v249, s78
    v_min_u32 v240, 39, v230
    v_lshl_add_u32 v250, v240, 8, s39
    s_waitcnt vmcnt(7)
    s_barrier
    ds_read_b128 v[0:3], v226 offset:0
    ds_read_b128 v[4:7], v227 offset:0
    ds_read_b128 v[8:11], v228 offset:0
    ds_read_b128 v[12:15], v229 offset:0
    s_lshl_b32 s30, s4, 13
    s_add_u32 s30, s30, 110912
    v_lshl_add_u32 v252, v230, 4, s30
    v_lshlrev_b32 v253, 4, v230
    v_add_u32 v253, 143680, v253
    ds_read_b128 v[144:147], v252 offset:0
    ds_read_b128 v[148:151], v252 offset:1024
    ds_read_b128 v[152:155], v252 offset:2048
    ds_read_b128 v[156:159], v252 offset:3072
    ds_read_b128 v[128:131], v253 offset:0
    ds_read_b128 v[132:135], v253 offset:1024
    ds_read_b128 v[136:139], v253 offset:2048
    ds_read_b128 v[140:143], v253 offset:3072
    s_add_u32 s31, s8, 1
    s_and_b32 s31, s31, 7
    s_mul_i32 s31, s31, 176128
    s_add_u32 s31, s31, s26
    s_add_u32 m0, s27, 73856
    s_nop 0
    buffer_load_dwordx4 v231, s[16:19], s31 offen lds
    s_add_u32 m0, s27, 74880
    s_nop 0
    buffer_load_dwordx4 v232, s[16:19], s31 offen lds
    s_add_u32 m0, s27, 75904
    s_nop 0
    buffer_load_dwordx4 v233, s[16:19], s31 offen lds
    s_waitcnt vmcnt(7) lgkmcnt(0)
    s_barrier
    s_lshl_b32 s30, s7, 3
    s_lshl_b32 s31, s4, 1
    s_add_u32 s30, s30, s31
    s_and_b32 s31, s30, 31
    s_lshl_b32 s31, s31, 6
    s_add_u32 s31, s31, s6
    s_add_u32 s31, s31, s6
    s_bfe_u32 s75, s30, 0x10005
    s_add_u32 s31, s31, s75
    s_bfe_u32 s75, s30, 0x10006
    s_lshl_b32 s75, s75, 5
    s_add_u32 s31, s31, s75
    s_lshl_b32 s31, s31, 10
    v_lshlrev_b32 v251, 4, v230
    s_lshl_b32 s25, s4, 11
    s_add_u32 m0, s25, 152064
    s_nop 0
    buffer_load_dwordx4 v251, s[12:15], s31 offen lds
    s_add_u32 m0, s25, 153088
    s_add_u32 s31, s31, 0x10000
    buffer_load_dwordx4 v251, s[12:15], s31 offen lds
    s_add_u32 s31, s8, 1
    s_and_b32 s31, s31, 7
    s_mul_i32 s31, s31, 176128
    s_add_u32 s31, s31, s9
    s_add_u32 m0, s27, 86208
    s_nop 0
    buffer_load_dwordx4 v231, s[16:19], s31 offen lds
    s_add_u32 m0, s27, 87232
    s_nop 0
    buffer_load_dwordx4 v232, s[16:19], s31 offen lds
    s_add_u32 m0, s27, 88256
    s_nop 0
    buffer_load_dwordx4 v233, s[16:19], s31 offen lds
    s_add_u32 s30, s8, 2
    s_and_b32 s30, s30, 7
    s_lshl_b32 s30, s30, 7
    s_add_u32 s30, s30, s28
    s_add_u32 m0, s74, 32768
    s_nop 0
    buffer_load_dwordx4 v224, s[12:15], s30 offen lds
    s_add_u32 m0, s74, 33792
    s_add_u32 s30, s30, 0x80000
    buffer_load_dwordx4 v225, s[12:15], s30 offen lds
    s_add_u32 s30, s8, 2
    s_and_b32 s30, s30, 7
    s_lshl_b32 s30, s30, 7
    s_add_u32 s30, s30, s34
    s_add_u32 m0, s55, 32768
    s_nop 0
    buffer_load_dwordx4 v224, s[12:15], s30 offen lds
    s_add_u32 m0, s55, 33792
    s_add_u32 s30, s30, 0x80000
    buffer_load_dwordx4 v225, s[12:15], s30 offen lds
    s_add_u32 s31, s8, 2
    s_and_b32 s31, s31, 7
    s_mul_i32 s31, s31, 176128
    s_add_u32 s31, s31, s26
    s_add_u32 m0, s27, 98560
    s_nop 0
    buffer_load_dwordx4 v231, s[16:19], s31 offen lds
    s_add_u32 m0, s27, 99584
    s_nop 0
    buffer_load_dwordx4 v232, s[16:19], s31 offen lds
    s_add_u32 m0, s27, 100608
    s_nop 0
    buffer_load_dwordx4 v233, s[16:19], s31 offen lds
    s_waitcnt vmcnt(7)
    s_barrier
    ds_read_b128 v[16:19], v226 offset:16384
    ds_read_b128 v[20:23], v227 offset:16384
    ds_read_b128 v[24:27], v228 offset:16384
    ds_read_b128 v[28:31], v229 offset:16384
    v_mov_b32 v235, 0
    s_add_u32 s30, s25, 152064
    v_lshl_add_u32 v252, v230, 5, s30
    ds_read_b128 v[176:179], v252
    ds_read_b128 v[180:183], v252 offset:16
    global_load_dwordx2 v[236:237], v235, s[62:63] sc1
    s_add_u32 s31, s8, 2
    s_and_b32 s31, s31, 7
    s_mul_i32 s31, s31, 176128
    s_add_u32 s31, s31, s9
    s_add_u32 m0, s27, 110912
    s_nop 0
    buffer_load_dwordx4 v231, s[16:19], s31 offen lds
    s_waitcnt lgkmcnt(0)
    v_lshlrev_b32 v208, 16, v176
    v_and_b32 v209, s32, v176
    v_lshlrev_b32 v210, 16, v177
    v_and_b32 v211, s32, v177
    v_lshlrev_b32 v212, 16, v178
    v_and_b32 v213, s32, v178
    v_lshlrev_b32 v214, 16, v179
    v_and_b32 v215, s32, v179
    v_lshlrev_b32 v216, 16, v180
    v_and_b32 v217, s32, v180
    v_lshlrev_b32 v218, 16, v181
    v_and_b32 v219, s32, v181
    s_add_u32 m0, s27, 111936
    s_nop 0
    buffer_load_dwordx4 v232, s[16:19], s31 offen lds
    v_lshlrev_b32 v220, 16, v182
    v_and_b32 v221, s32, v182
    v_lshlrev_b32 v222, 16, v183
    v_and_b32 v223, s32, v183
    v_add_f32 v176, v208, v209
    v_add_f32 v177, v210, v211
    v_add_f32 v178, v212, v213
    v_add_f32 v179, v214, v215
    v_add_f32 v180, v216, v217
    v_add_f32 v181, v218, v219
    v_add_f32 v182, v220, v221
    v_add_f32 v183, v222, v223
    s_add_u32 m0, s27, 112960
    s_nop 0
    buffer_load_dwordx4 v233, s[16:19], s31 offen lds
    v_add_f32 v176, v176, v180
    v_add_f32 v177, v177, v181
    v_add_f32 v178, v178, v182
    v_add_f32 v179, v179, v183
    v_add_f32 v176, v176, v178
    v_add_f32 v177, v177, v179
    v_add_f32 v184, v176, v177
    s_nop 1
    v_add_f32_dpp v184, v184, v184 quad_perm:[1,0,3,2] row_mask:0xf bank_mask:0xf
    s_nop 1
    v_add_f32_dpp v184, v184, v184 quad_perm:[2,3,0,1] row_mask:0xf bank_mask:0xf
    s_nop 1
    s_add_u32 s30, s8, 3
    s_and_b32 s30, s30, 7
    s_lshl_b32 s30, s30, 7
    s_add_u32 s30, s30, s28
    s_add_u32 m0, s74, 0
    s_nop 0
    buffer_load_dwordx4 v224, s[12:15], s30 offen lds
    v_add_f32_dpp v184, v184, v184 row_half_mirror row_mask:0xf bank_mask:0xf
    s_nop 1
    v_add_f32_dpp v184, v184, v184 row_mirror row_mask:0xf bank_mask:0xf
    v_mov_b32 v185, v184
    s_nop 1
    v_permlane16_swap_b32 v184, v185
    s_nop 1
    v_add_f32 v184, v184, v185
    v_mul_f32 v184, 0xbb000000, v184
    v_add_f32 v208, v208, v184
    v_add_f32 v209, v209, v184
    v_add_f32 v210, v210, v184
    s_add_u32 m0, s74, 1024
    s_add_u32 s30, s30, 0x80000
    buffer_load_dwordx4 v225, s[12:15], s30 offen lds
    v_add_f32 v211, v211, v184
    v_add_f32 v212, v212, v184
    v_add_f32 v213, v213, v184
    v_add_f32 v214, v214, v184
    v_add_f32 v215, v215, v184
    v_add_f32 v216, v216, v184
    s_add_u32 s30, s8, 3
    s_and_b32 s30, s30, 7
    s_lshl_b32 s30, s30, 7
    s_add_u32 s30, s30, s34
    s_add_u32 m0, s55, 0
    s_nop 0
    buffer_load_dwordx4 v224, s[12:15], s30 offen lds
    s_add_u32 m0, s55, 1024
    s_add_u32 s30, s30, 0x80000
    buffer_load_dwordx4 v225, s[12:15], s30 offen lds
    s_add_u32 s31, s8, 3
    s_and_b32 s31, s31, 7
    s_mul_i32 s31, s31, 176128
    s_add_u32 s31, s31, s26
    s_add_u32 m0, s27, 123264
    s_nop 0
    buffer_load_dwordx4 v231, s[16:19], s31 offen lds
    s_add_u32 m0, s27, 124288
    s_nop 0
    buffer_load_dwordx4 v232, s[16:19], s31 offen lds
    s_add_u32 m0, s27, 125312
    s_nop 0
    buffer_load_dwordx4 v233, s[16:19], s31 offen lds
    s_waitcnt vmcnt(7)
    s_barrier
    ds_read_b128 v[32:35], v226 offset:32768
    ds_read_b128 v[36:39], v227 offset:32768
    ds_read_b128 v[40:43], v228 offset:32768
    ds_read_b128 v[44:47], v229 offset:32768
    s_add_u32 s31, s8, 3
    s_and_b32 s31, s31, 7
    s_mul_i32 s31, s31, 176128
    s_add_u32 s31, s31, s9
    s_add_u32 m0, s27, 135616
    s_nop 0
    buffer_load_dwordx4 v231, s[16:19], s31 offen lds
    v_add_f32 v217, v217, v184
    v_add_f32 v218, v218, v184
    v_add_f32 v219, v219, v184
    v_add_f32 v220, v220, v184
    v_add_f32 v221, v221, v184
    v_add_f32 v222, v222, v184
    v_add_f32 v223, v223, v184
    v_mul_f32 v176, v208, v208
    v_mul_f32 v177, v209, v209
    v_mul_f32 v178, v210, v210
    v_mul_f32 v179, v211, v211
    v_fmac_f32 v176, v212, v212
    s_add_u32 m0, s27, 136640
    s_nop 0
    buffer_load_dwordx4 v232, s[16:19], s31 offen lds
    v_fmac_f32 v177, v213, v213
    v_fmac_f32 v178, v214, v214
    v_fmac_f32 v179, v215, v215
    v_fmac_f32 v176, v216, v216
    v_fmac_f32 v177, v217, v217
    v_fmac_f32 v178, v218, v218
    v_fmac_f32 v179, v219, v219
    v_fmac_f32 v176, v220, v220
    v_fmac_f32 v177, v221, v221
    v_fmac_f32 v178, v222, v222
    v_fmac_f32 v179, v223, v223
    v_add_f32 v176, v176, v177
    s_add_u32 m0, s27, 137664
    s_nop 0
    buffer_load_dwordx4 v233, s[16:19], s31 offen lds
    v_add_f32 v178, v178, v179
    v_add_f32 v186, v176, v178
    s_nop 1
    v_add_f32_dpp v186, v186, v186 quad_perm:[1,0,3,2] row_mask:0xf bank_mask:0xf
    s_nop 1
    v_add_f32_dpp v186, v186, v186 quad_perm:[2,3,0,1] row_mask:0xf bank_mask:0xf
    s_nop 1
    v_add_f32_dpp v186, v186, v186 row_half_mirror row_mask:0xf bank_mask:0xf
    s_nop 1
    v_add_f32_dpp v186, v186, v186 row_mirror row_mask:0xf bank_mask:0xf
    v_mov_b32 v187, v186
    s_nop 1
    s_add_u32 s30, s8, 4
    s_and_b32 s30, s30, 7
    s_lshl_b32 s30, s30, 7
    s_add_u32 s30, s30, s28
    s_add_u32 m0, s74, 16384
    s_nop 0
    buffer_load_dwordx4 v224, s[12:15], s30 offen lds
    v_permlane16_swap_b32 v186, v187
    s_nop 1
    v_add_f32 v186, v186, v187
    v_mul_f32 v186, 0x3b000000, v186
    v_cvt_pk_bf16_f32 v186, v186, v186
    v_and_b32 v186, s32, v186
    v_add_f32 v186, 0x3727c5ac, v186
    v_cvt_pk_bf16_f32 v186, v186, v186
    v_and_b32 v186, s32, v186
    v_sqrt_f32 v186, v186
    s_nop 0
    v_cvt_pk_bf16_f32 v188, v184, v186
    s_add_u32 m0, s74, 17408
    s_add_u32 s30, s30, 0x80000
    buffer_load_dwordx4 v225, s[12:15], s30 offen lds
    v_lshlrev_b32 v190, 16, v188
    v_sub_f32 v190, v190, v184
    v_mul_f32 v190, 0x44000000, v190
    s_add_u32 s30, s8, 4
    s_and_b32 s30, s30, 7
    s_lshl_b32 s30, s30, 7
    s_add_u32 s30, s30, s34
    s_add_u32 m0, s55, 16384
    s_nop 0
    buffer_load_dwordx4 v224, s[12:15], s30 offen lds
    s_add_u32 m0, s55, 17408
    s_add_u32 s30, s30, 0x80000
    buffer_load_dwordx4 v225, s[12:15], s30 offen lds
    s_add_u32 s31, s8, 4
    s_and_b32 s31, s31, 7
    s_mul_i32 s31, s31, 176128
    s_add_u32 s31, s31, s26
    s_add_u32 m0, s27, 49152
    s_nop 0
    buffer_load_dwordx4 v231, s[16:19], s31 offen lds
    s_add_u32 m0, s27, 50176
    s_nop 0
    buffer_load_dwordx4 v232, s[16:19], s31 offen lds
    s_add_u32 m0, s27, 51200
    s_nop 0
    buffer_load_dwordx4 v233, s[16:19], s31 offen lds
    v_readfirstlane_b32 s60, v236
    v_readfirstlane_b32 s61, v237
    s_cmp_lg_u32 s60, 0
    s_cbranch_scc1 L_hn_1
    v_mov_b32 v235, 0
    s_mov_b32 s76, 0
L_nn_2:
    global_load_dwordx2 v[236:237], v235, s[62:63] sc1
    s_waitcnt vmcnt(0)
    v_readfirstlane_b32 s60, v236
    v_readfirstlane_b32 s61, v237
    s_cmp_lg_u32 s60, 0
    s_cbranch_scc1 L_nnd_3
    s_sleep 2
    s_add_u32 s76, s76, 1
    s_cmp_lt_u32 s76, 1048576
    s_cbranch_scc1 L_nn_2
L_nnd_3:
L_hn_1:
    s_nop 1
    s_lshl_b32 s30, s4, 5
    s_add_u32 s30, s30, 163328
    v_lshrrev_b32 v252, 5, v230
    v_lshl_add_u32 v252, v252, 4, s30
    s_mov_b32 s5, 0x01000100
    v_mov_b32 v189, s60
    v_mov_b32 v191, s60
    ds_write_b128 v252, v[188:191]
    v_mov_b32 v254, 160912
    v_mov_b32 v236, s60
    v_mov_b32 v237, s61
    ds_write_b64 v254, v[236:237]
    s_waitcnt vmcnt(7) lgkmcnt(0)
    s_barrier
    ds_read_b128 v[48:51], v226 offset:0
    ds_read_b128 v[52:55], v227 offset:0
    ds_read_b128 v[56:59], v228 offset:0
    ds_read_b128 v[60:63], v229 offset:0
    s_add_u32 s31, s8, 4
    s_and_b32 s31, s31, 7
    s_mul_i32 s31, s31, 176128
    s_add_u32 s31, s31, s9
    s_add_u32 m0, s27, 61504
    s_nop 0
    buffer_load_dwordx4 v231, s[16:19], s31 offen lds
    s_add_u32 m0, s27, 62528
    s_nop 0
    buffer_load_dwordx4 v232, s[16:19], s31 offen lds
    s_add_u32 m0, s27, 63552
    s_nop 0
    buffer_load_dwordx4 v233, s[16:19], s31 offen lds
    s_add_u32 s30, s8, 5
    s_and_b32 s30, s30, 7
    s_lshl_b32 s30, s30, 7
    s_add_u32 s30, s30, s28
    s_add_u32 m0, s74, 32768
    s_nop 0
    buffer_load_dwordx4 v224, s[12:15], s30 offen lds
    s_add_u32 m0, s74, 33792
    s_add_u32 s30, s30, 0x80000
    buffer_load_dwordx4 v225, s[12:15], s30 offen lds
    s_add_u32 s30, s8, 5
    s_and_b32 s30, s30, 7
    s_lshl_b32 s30, s30, 7
    s_add_u32 s30, s30, s34
    s_add_u32 m0, s55, 32768
    s_nop 0
    buffer_load_dwordx4 v224, s[12:15], s30 offen lds
    s_add_u32 m0, s55, 33792
    s_add_u32 s30, s30, 0x80000
    buffer_load_dwordx4 v225, s[12:15], s30 offen lds
    s_add_u32 s31, s8, 5
    s_and_b32 s31, s31, 7
    s_mul_i32 s31, s31, 176128
    s_add_u32 s31, s31, s26
    s_add_u32 m0, s27, 73856
    s_nop 0
    buffer_load_dwordx4 v231, s[16:19], s31 offen lds
    s_add_u32 m0, s27, 74880
    s_nop 0
    buffer_load_dwordx4 v232, s[16:19], s31 offen lds
    s_add_u32 m0, s27, 75904
    s_nop 0
    buffer_load_dwordx4 v233, s[16:19], s31 offen lds
    v_mov_b32 v254, 160912
    s_cmp_lt_u32 s4, 2
    s_cbranch_scc1 L_pc_5
    s_cmp_eq_u32 s4, 3
    s_cbranch_scc1 L_pg_4
    v_add_u32 v216, 161280, v251
    ds_read_b128 v[208:211], v216
    ds_read_b128 v[212:215], v216 offset:1024
    ds_read_b32 v217, v254
    s_lshl_b32 s30, s7, 4
    s_add_u32 s30, s30, s6
    s_lshl_b32 s30, s30, 10
    s_add_u32 s30, s30, 8912896
    v_add_u32 v216, s30, v251
    s_waitcnt lgkmcnt(0)
    v_add_f32 v208, v208, v212
    v_add_f32 v209, v209, v213
    v_add_f32 v210, v210, v214
    v_mov_b32 v211, v217
    global_store_dwordx4 v216, v[208:211], s[10:11] sc1
    s_branch L_pc_5
L_pg_4:
    v_and_b32 v216, 0x7f, v251
    v_add_u32 v217, 163328, v216
    ds_read_b128 v[208:211], v217
    s_lshl_b32 s30, s6, 4
    s_add_u32 s30, s30, s7
    s_lshl_b32 s30, s30, 7
    s_add_u32 s30, s30, 9437184
    v_add_u32 v216, s30, v216
    s_mov_b64 exec, 0xff
    s_waitcnt lgkmcnt(0)
    global_store_dwordx4 v216, v[208:211], s[10:11] sc1
    s_mov_b64 exec, -1
L_pc_5:
    s_waitcnt vmcnt(7) lgkmcnt(0)
    s_barrier
    ds_read_b128 v[64:67], v226 offset:16384
    ds_read_b128 v[68:71], v227 offset:16384
    ds_read_b128 v[72:75], v228 offset:16384
    ds_read_b128 v[76:79], v229 offset:16384
    s_add_u32 s31, s8, 5
    s_and_b32 s31, s31, 7
    s_mul_i32 s31, s31, 176128
    s_add_u32 s31, s31, s9
    s_add_u32 m0, s27, 86208
    s_nop 0
    buffer_load_dwordx4 v231, s[16:19], s31 offen lds
    s_add_u32 m0, s27, 87232
    s_nop 0
    buffer_load_dwordx4 v232, s[16:19], s31 offen lds
    s_add_u32 m0, s27, 88256
    s_nop 0
    buffer_load_dwordx4 v233, s[16:19], s31 offen lds
    s_add_u32 s30, s8, 6
    s_and_b32 s30, s30, 7
    s_lshl_b32 s30, s30, 7
    s_add_u32 s30, s30, s28
    s_add_u32 m0, s74, 0
    s_nop 0
    buffer_load_dwordx4 v224, s[12:15], s30 offen lds
    s_add_u32 m0, s74, 1024
    s_add_u32 s30, s30, 0x80000
    buffer_load_dwordx4 v225, s[12:15], s30 offen lds
    s_add_u32 s30, s8, 6
    s_and_b32 s30, s30, 7
    s_lshl_b32 s30, s30, 7
    s_add_u32 s30, s30, s34
    s_add_u32 m0, s55, 0
    s_nop 0
    buffer_load_dwordx4 v224, s[12:15], s30 offen lds
    s_add_u32 m0, s55, 1024
    s_add_u32 s30, s30, 0x80000
    buffer_load_dwordx4 v225, s[12:15], s30 offen lds
    s_add_u32 s31, s8, 6
    s_and_b32 s31, s31, 7
    s_mul_i32 s31, s31, 176128
    s_add_u32 s31, s31, s26
    s_add_u32 m0, s27, 98560
    s_nop 0
    buffer_load_dwordx4 v231, s[16:19], s31 offen lds
    s_add_u32 m0, s27, 99584
    s_nop 0
    buffer_load_dwordx4 v232, s[16:19], s31 offen lds
    s_add_u32 m0, s27, 100608
    s_nop 0
    buffer_load_dwordx4 v233, s[16:19], s31 offen lds
    s_waitcnt vmcnt(7) lgkmcnt(0)
    s_barrier
    ds_read_b128 v[80:83], v226 offset:32768
    ds_read_b128 v[84:87], v227 offset:32768
    ds_read_b128 v[88:91], v228 offset:32768
    ds_read_b128 v[92:95], v229 offset:32768
    s_add_u32 s31, s8, 6
    s_and_b32 s31, s31, 7
    s_mul_i32 s31, s31, 176128
    s_add_u32 s31, s31, s9
    s_add_u32 m0, s27, 110912
    s_nop 0
    buffer_load_dwordx4 v231, s[16:19], s31 offen lds
    s_add_u32 m0, s27, 111936
    s_nop 0
    buffer_load_dwordx4 v232, s[16:19], s31 offen lds
    s_add_u32 m0, s27, 112960
    s_nop 0
    buffer_load_dwordx4 v233, s[16:19], s31 offen lds
    s_add_u32 s30, s8, 7
    s_and_b32 s30, s30, 7
    s_lshl_b32 s30, s30, 7
    s_add_u32 s30, s30, s28
    s_add_u32 m0, s74, 16384
    s_nop 0
    buffer_load_dwordx4 v224, s[12:15], s30 offen lds
    s_add_u32 m0, s74, 17408
    s_add_u32 s30, s30, 0x80000
    buffer_load_dwordx4 v225, s[12:15], s30 offen lds
    s_add_u32 s30, s8, 7
    s_and_b32 s30, s30, 7
    s_lshl_b32 s30, s30, 7
    s_add_u32 s30, s30, s34
    s_add_u32 m0, s55, 16384
    s_nop 0
    buffer_load_dwordx4 v224, s[12:15], s30 offen lds
    s_add_u32 m0, s55, 17408
    s_add_u32 s30, s30, 0x80000
    buffer_load_dwordx4 v225, s[12:15], s30 offen lds
    s_add_u32 s31, s8, 7
    s_and_b32 s31, s31, 7
    s_mul_i32 s31, s31, 176128
    s_add_u32 s31, s31, s26
    s_add_u32 m0, s27, 123264
    s_nop 0
    buffer_load_dwordx4 v231, s[16:19], s31 offen lds
    s_add_u32 m0, s27, 124288
    s_nop 0
    buffer_load_dwordx4 v232, s[16:19], s31 offen lds
    s_add_u32 m0, s27, 125312
    s_nop 0
    buffer_load_dwordx4 v233, s[16:19], s31 offen lds
    s_waitcnt vmcnt(7) lgkmcnt(0)
    s_barrier
    ds_read_b128 v[96:99], v226 offset:0
    ds_read_b128 v[100:103], v227 offset:0
    ds_read_b128 v[104:107], v228 offset:0
    ds_read_b128 v[108:111], v229 offset:0
    s_add_u32 s31, s8, 7
    s_and_b32 s31, s31, 7
    s_mul_i32 s31, s31, 176128
    s_add_u32 s31, s31, s9
    s_add_u32 m0, s27, 135616
    s_nop 0
    buffer_load_dwordx4 v231, s[16:19], s31 offen lds
    s_add_u32 m0, s27, 136640
    s_nop 0
    buffer_load_dwordx4 v232, s[16:19], s31 offen lds
    s_add_u32 m0, s27, 137664
    s_nop 0
    buffer_load_dwordx4 v233, s[16:19], s31 offen lds
    global_load_dwordx4 v[188:191], v248, s[10:11] sc1
    s_lshl_b32 s30, s7, 14
    s_lshl_b32 s31, s4, 12
    s_add_u32 s30, s30, s31
    s_add_u32 s30, s30, 8912896
    v_add_u32 v235, s30, v251
    global_load_dwordx4 v[208:211], v235, s[10:11] offset:0 sc1
    global_load_dwordx4 v[212:215], v235, s[10:11] offset:1024 sc1
    global_load_dwordx4 v[216:219], v235, s[10:11] offset:2048 sc1
    global_load_dwordx4 v[220:223], v235, s[10:11] offset:3072 sc1
    s_add_u32 s30, s72, 0
    s_and_b32 s30, s30, 31
    s_and_b32 s31, s30, 28
    s_lshr_b32 s31, s54, s31
    s_and_b32 s31, s31, 15
    s_add_u32 s31, s31, s30
    s_bfe_u32 s30, s30, 0x10001
    s_add_u32 s30, s30, s31
    s_lshl_b32 s30, s30, 14
    s_add_u32 m0, s53, 49152
    s_add_u32 s44, s30, s52
    buffer_load_dwordx4 v234, s[64:67], s44 offen lds
    s_add_u32 m0, s53, 53248
    s_add_u32 s44, s44, 16384
    buffer_load_dwordx4 v234, s[64:67], s44 offen lds
    s_add_u32 m0, s53, 57344
    s_add_u32 s44, s44, 32768
    buffer_load_dwordx4 v234, s[64:67], s44 offen lds
    s_add_u32 m0, s53, 61440
    s_add_u32 s44, s44, 16384
    buffer_load_dwordx4 v234, s[64:67], s44 offen lds
    s_waitcnt vmcnt(9) lgkmcnt(0)
    s_barrier
    ds_read_b128 v[112:115], v226 offset:16384
    ds_read_b128 v[116:119], v227 offset:16384
    ds_read_b128 v[120:123], v228 offset:16384
    ds_read_b128 v[124:127], v229 offset:16384
    s_setprio 3
    s_waitcnt vmcnt(4)
    s_mov_b32 s76, 0
L_cg_6:
    v_and_b32 v240, v189, v191
    v_or3_b32 v242, v189, v191, v211
    v_bitop3_b32 v240, v240, v211, v215 bitop3:0x80
    v_or3_b32 v242, v242, v215, v219
    v_bitop3_b32 v240, v240, v219, v223 bitop3:0x80
    v_or_b32 v242, v242, v223
    v_cmp_ne_u32 vcc, s60, v240
    v_cmp_ne_u32 s[78:79], s60, v242
    s_or_b64 vcc, vcc, s[78:79]
    s_cbranch_scc0 L_cgd_7
    global_load_dwordx4 v[188:191], v248, s[10:11] sc1
    global_load_dwordx4 v[208:211], v235, s[10:11] offset:0 sc1
    global_load_dwordx4 v[212:215], v235, s[10:11] offset:1024 sc1
    global_load_dwordx4 v[216:219], v235, s[10:11] offset:2048 sc1
    global_load_dwordx4 v[220:223], v235, s[10:11] offset:3072 sc1
    s_add_u32 s76, s76, 1
    s_cmp_lt_u32 s76, 1048576
    s_waitcnt vmcnt(0)
    s_cbranch_scc1 L_cg_6
L_cgd_7:
    v_and_b32 v178, s32, v188
    v_rcp_f32 v180, v178
    v_add_f32 v208, v208, v212
    v_add_f32 v216, v216, v220
    v_add_f32 v209, v209, v213
    v_add_f32 v217, v217, v221
    v_add_f32 v210, v210, v214
    v_add_f32 v218, v218, v222
    v_perm_b32 v179, v188, v188, s5
    v_mul_f32 v176, 0xc0135761, v180
    v_mul_f32 v177, v180, v180
    v_mul_f32 v178, v178, v178
    v_mul_f32 v177, v177, v176
    v_mul_f32 v177, 0x3d372713, v177
    ds_write_b128 v238, v[176:179]
    v_add_f32 v208, v208, v216
    v_add_f32 v209, v209, v217
    v_add_f32 v210, v210, v218
    v_and_b32 v212, s32, v208
    v_and_b32 v213, s32, v209
    v_and_b32 v214, s32, v210
    v_sub_f32 v208, v208, v212
    v_sub_f32 v209, v209, v213
    v_sub_f32 v210, v210, v214
    v_cvt_pk_bf16_f32 v212, v212, v208
    v_cvt_pk_bf16_f32 v213, v213, v209
    v_cvt_pk_bf16_f32 v214, v214, v210
    ds_write_b32 v239, v212 offset:0
    ds_write_b32 v239, v213 offset:512
    ds_write_b32 v239, v214 offset:1024
    ds_write_b32 v249, v249
    s_setprio 3
    v_and_b32 v240, 31, v230
    v_lshl_add_u32 v241, v240, 2, s48
    ds_write_b32 v241, v180
    s_cmp_lg_u32 s7, 3
    s_cbranch_scc1 L_c0_8
    v_mul_f32 v190, v190, v180
    v_add_u32 v241, 0xffffde00, v241
    ds_write_b32 v241, v190
    v_lshrrev_b32 v240, 5, v230
    s_add_u32 s30, s48, 0xffffde00
    v_lshl_add_u32 v242, v240, 4, s30
    ds_read_b128 v[192:195], v242 offset:0
    ds_read_b128 v[196:199], v242 offset:32
    ds_read_b128 v[200:203], v242 offset:64
    ds_read_b128 v[204:207], v242 offset:96
    v_bfe_u32 v243, v230, 4, 1
    v_cmp_eq_u32 vcc, 0, v243
    s_add_u32 s30, s77, 147968
    v_lshl_add_u32 v240, v240, 6, s30
    v_lshl_add_u32 v240, v243, 1, v240
    s_waitcnt lgkmcnt(0)
    v_cvt_pk_bf16_f32 v208, v192, v193
    v_cvt_pk_bf16_f32 v209, v194, v195
    v_cvt_pk_bf16_f32 v210, v196, v197
    v_cvt_pk_bf16_f32 v211, v198, v199
    v_cvt_pk_bf16_f32 v212, v200, v201
    v_cvt_pk_bf16_f32 v213, v202, v203
    v_cvt_pk_bf16_f32 v214, v204, v205
    v_cvt_pk_bf16_f32 v215, v206, v207
    v_xor_b32 v216, 0x80008000, v208
    v_xor_b32 v217, 0x80008000, v209
    v_xor_b32 v218, 0x80008000, v210
    v_xor_b32 v219, 0x80008000, v211
    v_xor_b32 v220, 0x80008000, v212
    v_xor_b32 v221, 0x80008000, v213
    v_xor_b32 v222, 0x80008000, v214
    v_xor_b32 v223, 0x80008000, v215
    v_cndmask_b32 v208, 0, v208, vcc
    v_cndmask_b32 v216, v216, 0, vcc
    v_cndmask_b32 v209, 0, v209, vcc
    v_cndmask_b32 v217, v217, 0, vcc
    v_cndmask_b32 v210, 0, v210, vcc
    v_cndmask_b32 v218, v218, 0, vcc
    v_cndmask_b32 v211, 0, v211, vcc
    v_cndmask_b32 v219, v219, 0, vcc
    v_cndmask_b32 v212, 0, v212, vcc
    v_cndmask_b32 v220, v220, 0, vcc
    v_cndmask_b32 v213, 0, v213, vcc
    v_cndmask_b32 v221, v221, 0, vcc
    v_cndmask_b32 v214, 0, v214, vcc
    v_cndmask_b32 v222, v222, 0, vcc
    v_cndmask_b32 v215, 0, v215, vcc
    v_cndmask_b32 v223, v223, 0, vcc
    s_nop 1
    v_mfma_f32_32x32x16_bf16 v[192:207], v[128:131], v[208:211], 0
    v_mfma_f32_32x32x16_bf16 v[192:207], v[132:135], v[212:215], v[192:207]
    v_mfma_f32_32x32x16_bf16 v[192:207], v[136:139], v[216:219], v[192:207]
    v_mfma_f32_32x32x16_bf16 v[192:207], v[140:143], v[220:223], v[192:207]
    s_nop 11
    v_cvt_pk_bf16_f32 v208, v192, v193
    v_cvt_pk_bf16_f32 v209, v194, v195
    v_cvt_pk_bf16_f32 v210, v196, v197
    v_cvt_pk_bf16_f32 v211, v198, v199
    v_cvt_pk_bf16_f32 v212, v200, v201
    v_cvt_pk_bf16_f32 v213, v202, v203
    v_cvt_pk_bf16_f32 v214, v204, v205
    v_cvt_pk_bf16_f32 v215, v206, v207
    ds_write_b16 v240, v208 offset:0
    ds_write_b16_d16_hi v240, v208 offset:16
    ds_write_b16 v240, v209 offset:32
    ds_write_b16_d16_hi v240, v209 offset:48
    ds_write_b16 v240, v210 offset:128
    ds_write_b16_d16_hi v240, v210 offset:144
    ds_write_b16 v240, v211 offset:160
    ds_write_b16_d16_hi v240, v211 offset:176
    ds_write_b16 v240, v212 offset:256
    ds_write_b16_d16_hi v240, v212 offset:272
    ds_write_b16 v240, v213 offset:288
    ds_write_b16_d16_hi v240, v213 offset:304
    ds_write_b16 v240, v214 offset:384
    ds_write_b16_d16_hi v240, v214 offset:400
    ds_write_b16 v240, v215 offset:416
    ds_write_b16_d16_hi v240, v215 offset:432
    s_waitcnt lgkmcnt(0)
L_c0_8:
    s_add_u32 s30, s72, 4
    s_and_b32 s30, s30, 31
    s_and_b32 s31, s30, 28
    s_lshr_b32 s31, s54, s31
    s_and_b32 s31, s31, 15
    s_add_u32 s31, s31, s30
    s_bfe_u32 s30, s30, 0x10001
    s_add_u32 s30, s30, s31
    s_lshl_b32 s30, s30, 14
    s_add_u32 m0, s53, 65536
    s_add_u32 s44, s30, s52
    buffer_load_dwordx4 v234, s[64:67], s44 offen lds
    s_add_u32 m0, s53, 69632
    s_add_u32 s44, s44, 16384
    buffer_load_dwordx4 v234, s[64:67], s44 offen lds
    s_add_u32 m0, s53, 73728
    s_add_u32 s44, s44, 32768
    buffer_load_dwordx4 v234, s[64:67], s44 offen lds
    s_add_u32 m0, s53, 77824
    s_add_u32 s44, s44, 16384
    buffer_load_dwordx4 v234, s[64:67], s44 offen lds
    s_add_u32 s75, s73, 0
    s_cmp_ge_u32 s75, 11
    s_cselect_b32 s30, 11, 0
    s_sub_u32 s75, s75, s30
    s_mul_i32 s30, s75, 5
    s_lshr_b64 s[30:31], s[46:47], s30
    s_and_b32 s30, s30, 31
    s_lshl_b32 s31, s75, 2
    s_cmp_lt_u32 s75, 8
    s_cselect_b32 s31, s31, 0
    s_add_u32 s30, s30, s31
    s_lshl_b32 s30, s30, 14
    s_add_u32 m0, s53, 81920
    s_add_u32 s44, s30, s52
    buffer_load_dwordx4 v234, s[64:67], s44 offen lds
    s_add_u32 s75, s73, 1
    s_cmp_ge_u32 s75, 11
    s_cselect_b32 s30, 11, 0
    s_sub_u32 s75, s75, s30
    s_mul_i32 s30, s75, 5
    s_lshr_b64 s[30:31], s[46:47], s30
    s_and_b32 s30, s30, 31
    s_lshl_b32 s31, s75, 2
    s_cmp_lt_u32 s75, 8
    s_cselect_b32 s31, s31, 0
    s_add_u32 s30, s30, s31
    s_lshl_b32 s30, s30, 14
    s_add_u32 m0, s53, 86016
    s_add_u32 s44, s30, s52
    buffer_load_dwordx4 v234, s[64:67], s44 offen lds
    s_add_u32 s75, s73, 2
    s_cmp_ge_u32 s75, 11
    s_cselect_b32 s30, 11, 0
    s_sub_u32 s75, s75, s30
    s_mul_i32 s30, s75, 5
    s_lshr_b64 s[30:31], s[46:47], s30
    s_and_b32 s30, s30, 31
    s_lshl_b32 s31, s75, 2
    s_cmp_lt_u32 s75, 8
    s_cselect_b32 s31, s31, 0
    s_add_u32 s30, s30, s31
    s_lshl_b32 s30, s30, 14
    s_add_u32 m0, s53, 90112
    s_add_u32 s44, s30, s52
    buffer_load_dwordx4 v234, s[64:67], s44 offen lds
    s_add_u32 s30, s72, 8
    s_and_b32 s30, s30, 31
    s_and_b32 s31, s30, 28
    s_lshr_b32 s31, s54, s31
    s_and_b32 s31, s31, 15
    s_add_u32 s31, s31, s30
    s_bfe_u32 s30, s30, 0x10001
    s_add_u32 s30, s30, s31
    s_lshl_b32 s30, s30, 14
    s_add_u32 m0, s53, 94208
    s_add_u32 s44, s30, s52
    buffer_load_dwordx4 v234, s[64:67], s44 offen lds
    v_and_b32 v254, 7, v230
    v_lshlrev_b32 v254, 2, v254
    v_add_u32 v254, 160928, v254
    s_mov_b32 s76, 0
L_sp_9:
    ds_read_b32 v255, v254
    s_waitcnt lgkmcnt(0)
    v_cmp_eq_u32 vcc, 0, v255
    s_cbranch_vccz L_spd_10
    s_sleep 1
    s_add_u32 s76, s76, 1
    s_cmp_lt_u32 s76, 1048576
    s_cbranch_scc1 L_sp_9
L_spd_10:
    s_add_u32 m0, s53, 98304
    s_add_u32 s44, s44, 16384
    buffer_load_dwordx4 v234, s[64:67], s44 offen lds
    s_add_u32 m0, s53, 102400
    s_add_u32 s44, s44, 32768
    buffer_load_dwordx4 v234, s[64:67], s44 offen lds
    s_add_u32 m0, s53, 106496
    s_add_u32 s44, s44, 16384
    buffer_load_dwordx4 v234, s[64:67], s44 offen lds
    s_add_u32 s30, s72, 12
    s_and_b32 s30, s30, 31
    s_and_b32 s31, s30, 28
    s_lshr_b32 s31, s54, s31
    s_and_b32 s31, s31, 15
    s_add_u32 s31, s31, s30
    s_bfe_u32 s30, s30, 0x10001
    s_add_u32 s30, s30, s31
    s_lshl_b32 s30, s30, 14
    s_add_u32 m0, s53, 110592
    s_add_u32 s44, s30, s52
    buffer_load_dwordx4 v234, s[64:67], s44 offen lds
    s_add_u32 m0, s53, 114688
    s_add_u32 s44, s44, 16384
    buffer_load_dwordx4 v234, s[64:67], s44 offen lds
    s_add_u32 m0, s53, 118784
    s_add_u32 s44, s44, 32768
    buffer_load_dwordx4 v234, s[64:67], s44 offen lds
    v_and_b32 v254, 3, v230
    v_lshlrev_b32 v254, 2, v254
    v_add_u32 v254, 160992, v254
    s_mov_b32 s76, 0
L_sp_11:
    ds_read_b32 v255, v254
    s_waitcnt lgkmcnt(0)
    v_cmp_eq_u32 vcc, 0, v255
    s_cbranch_vccz L_spd_12
    s_sleep 1
    s_add_u32 s76, s76, 1
    s_cmp_lt_u32 s76, 1048576
    s_cbranch_scc1 L_sp_11
L_spd_12:
    v_add_u32 v252, s53, v251
    ds_write_b128 v252, v[144:147] offset:32768
    ds_write_b128 v252, v[148:151] offset:36864
    ds_write_b128 v252, v[152:155] offset:40960
    ds_write_b128 v252, v[156:159] offset:45056
    s_add_u32 s30, s77, 160880
    v_mov_b32 v254, s30
    v_mov_b32 v255, 1
    ds_write_b32 v254, v255
    v_and_b32 v254, 3, v230
    v_lshlrev_b32 v254, 2, v254
    v_add_u32 v254, 160880, v254
    s_mov_b32 s76, 0
L_sp_13:
    ds_read_b32 v255, v254
    s_waitcnt lgkmcnt(0)
    v_cmp_eq_u32 vcc, 0, v255
    s_cbranch_vccz L_spd_14
    s_sleep 1
    s_add_u32 s76, s76, 1
    s_cmp_lt_u32 s76, 1048576
    s_cbranch_scc1 L_sp_13
L_spd_14:
    s_add_u32 s30, s77, 160896
    v_and_b32 v254, 0, v230
    v_lshlrev_b32 v254, 2, v254
    v_add_u32 v254, s30, v254
    s_mov_b32 s76, 0
L_sp_15:
    ds_read_b32 v255, v254
    s_waitcnt lgkmcnt(0)
    v_cmp_eq_u32 vcc, 0, v255
    s_cbranch_vccz L_spd_16
    s_sleep 1
    s_add_u32 s76, s76, 1
    s_cmp_lt_u32 s76, 1048576
    s_cbranch_scc1 L_sp_15
L_spd_16:
    ds_read_b128 v[192:195], v251 offset:32768
    ds_read_b128 v[196:199], v251 offset:33792
    ds_read_b128 v[200:203], v251 offset:34816
    ds_read_b128 v[204:207], v251 offset:35840
    ds_read_b128 v[208:211], v251 offset:36864
    ds_read_b128 v[212:215], v251 offset:37888
    s_waitcnt lgkmcnt(5)
    v_mfma_f32_32x32x16_bf16 v[176:191], v[0:3], v[192:195], 0
    ds_read_b128 v[216:219], v251 offset:38912
    v_mfma_f32_32x32x16_bf16 v[160:175], v[64:67], v[192:195], 0
    s_add_u32 m0, s53, 122880
    s_add_u32 s44, s44, 16384
    buffer_load_dwordx4 v234, s[64:67], s44 offen lds
    s_waitcnt lgkmcnt(5)
    v_mfma_f32_32x32x16_bf16 v[176:191], v[4:7], v[196:199], v[176:191]
    ds_read_b128 v[192:195], v251 offset:39936
    s_waitcnt vmcnt(12)
    s_add_u32 s30, s77, 160816
    v_mov_b32 v254, s30
    v_mov_b32 v255, 1
    ds_write_b32 v254, v255
    v_mfma_f32_32x32x16_bf16 v[160:175], v[68:71], v[196:199], v[160:175]
    s_add_u32 s30, s72, 16
    s_and_b32 s30, s30, 31
    s_and_b32 s31, s30, 28
    s_lshr_b32 s31, s54, s31
    s_and_b32 s31, s31, 15
    s_add_u32 s31, s31, s30
    s_bfe_u32 s30, s30, 0x10001
    s_add_u32 s30, s30, s31
    s_lshl_b32 s30, s30, 14
    s_add_u32 m0, s53, 126976
    s_add_u32 s44, s30, s52
    buffer_load_dwordx4 v234, s[64:67], s44 offen lds
    s_waitcnt lgkmcnt(6)
    v_mfma_f32_32x32x16_bf16 v[176:191], v[8:11], v[200:203], v[176:191]
    ds_read_b128 v[196:199], v251 offset:40960
    v_mfma_f32_32x32x16_bf16 v[160:175], v[72:75], v[200:203], v[160:175]
    s_add_u32 m0, s53, 131072
    s_add_u32 s44, s44, 16384
    buffer_load_dwordx4 v234, s[64:67], s44 offen lds
    s_waitcnt lgkmcnt(6)
    v_mfma_f32_32x32x16_bf16 v[176:191], v[12:15], v[204:207], v[176:191]
    ds_read_b128 v[200:203], v251 offset:41984
    v_mfma_f32_32x32x16_bf16 v[160:175], v[76:79], v[204:207], v[160:175]
    s_add_u32 m0, s53, 135168
    s_add_u32 s44, s44, 32768
    buffer_load_dwordx4 v234, s[64:67], s44 offen lds
    s_waitcnt lgkmcnt(6)
    v_mfma_f32_32x32x16_bf16 v[176:191], v[16:19], v[208:211], v[176:191]
    ds_read_b128 v[204:207], v251 offset:43008
    v_mfma_f32_32x32x16_bf16 v[160:175], v[80:83], v[208:211], v[160:175]
    s_add_u32 m0, s53, 139264
    s_add_u32 s44, s44, 16384
    buffer_load_dwordx4 v234, s[64:67], s44 offen lds
    s_waitcnt lgkmcnt(6)
    v_mfma_f32_32x32x16_bf16 v[176:191], v[20:23], v[212:215], v[176:191]
    ds_read_b128 v[208:211], v251 offset:44032
    v_mfma_f32_32x32x16_bf16 v[160:175], v[84:87], v[212:215], v[160:175]
    s_add_u32 s30, s72, 20
    s_and_b32 s30, s30, 31
    s_and_b32 s31, s30, 28
    s_lshr_b32 s31, s54, s31
    s_and_b32 s31, s31, 15
    s_add_u32 s31, s31, s30
    s_bfe_u32 s30, s30, 0x10001
    s_add_u32 s30, s30, s31
    s_lshl_b32 s30, s30, 14
    s_add_u32 m0, s53, 143360
    s_add_u32 s44, s30, s52
    buffer_load_dwordx4 v234, s[64:67], s44 offen lds
    s_waitcnt lgkmcnt(6)
    v_mfma_f32_32x32x16_bf16 v[176:191], v[24:27], v[216:219], v[176:191]
    ds_read_b128 v[212:215], v251 offset:45056
    v_mfma_f32_32x32x16_bf16 v[160:175], v[88:91], v[216:219], v[160:175]
    s_add_u32 m0, s53, 16384
    s_add_u32 s44, s44, 16384
    buffer_load_dwordx4 v234, s[64:67], s44 offen lds
    s_waitcnt lgkmcnt(6)
    v_mfma_f32_32x32x16_bf16 v[176:191], v[28:31], v[192:195], v[176:191]
    ds_read_b128 v[216:219], v251 offset:46080
    v_mfma_f32_32x32x16_bf16 v[160:175], v[92:95], v[192:195], v[160:175]
    s_add_u32 m0, s53, 20480
    s_add_u32 s44, s44, 32768
    buffer_load_dwordx4 v234, s[64:67], s44 offen lds
    s_waitcnt lgkmcnt(5)
    v_mfma_f32_32x32x16_bf16 v[176:191], v[32:35], v[196:199], v[176:191]
    ds_read_b128 v[192:195], v251 offset:47104
    v_mfma_f32_32x32x16_bf16 v[160:175], v[96:99], v[196:199], v[160:175]
    s_add_u32 m0, s53, 24576
    s_add_u32 s44, s44, 16384
    buffer_load_dwordx4 v234, s[64:67], s44 offen lds
    s_waitcnt lgkmcnt(5)
    v_mfma_f32_32x32x16_bf16 v[176:191], v[36:39], v[200:203], v[176:191]
    ds_read_b128 v[196:199], v251 offset:48128
    v_mfma_f32_32x32x16_bf16 v[160:175], v[100:103], v[200:203], v[160:175]
    s_add_u32 s30, s72, 24
    s_and_b32 s30, s30, 31
    s_and_b32 s31, s30, 28
    s_lshr_b32 s31, s54, s31
    s_and_b32 s31, s31, 15
    s_add_u32 s31, s31, s30
    s_bfe_u32 s30, s30, 0x10001
    s_add_u32 s30, s30, s31
    s_lshl_b32 s30, s30, 14
    s_add_u32 m0, s53, 28672
    s_add_u32 s44, s30, s52
    buffer_load_dwordx4 v234, s[64:67], s44 offen lds
    s_waitcnt lgkmcnt(5)
    v_mfma_f32_32x32x16_bf16 v[176:191], v[40:43], v[204:207], v[176:191]
    v_mfma_f32_32x32x16_bf16 v[160:175], v[104:107], v[204:207], v[160:175]
    s_add_u32 m0, s53, 0
    s_add_u32 s44, s44, 16384
    buffer_load_dwordx4 v234, s[64:67], s44 offen lds
    s_waitcnt lgkmcnt(4)
    v_mfma_f32_32x32x16_bf16 v[176:191], v[44:47], v[208:211], v[176:191]
    v_mfma_f32_32x32x16_bf16 v[160:175], v[108:111], v[208:211], v[160:175]
    s_add_u32 m0, s53, 4096
    s_add_u32 s44, s44, 32768
    buffer_load_dwordx4 v234, s[64:67], s44 offen lds
    s_waitcnt lgkmcnt(3)
    v_mfma_f32_32x32x16_bf16 v[176:191], v[48:51], v[212:215], v[176:191]
    v_mfma_f32_32x32x16_bf16 v[160:175], v[112:115], v[212:215], v[160:175]
    s_add_u32 m0, s53, 8192
    s_add_u32 s44, s44, 16384
    buffer_load_dwordx4 v234, s[64:67], s44 offen lds
    s_waitcnt lgkmcnt(2)
    v_mfma_f32_32x32x16_bf16 v[176:191], v[52:55], v[216:219], v[176:191]
    v_and_b32 v242, 1, v230
    v_cvt_f32_u32 v242, v242
    v_fma_f32 v242, v242, 2.0, -1.0
    v_lshrrev_b32 v240, 5, v230
    v_lshl_add_u32 v240, v240, 4, s48
    ds_read_b128 v[64:67], v240 offset:0
    ds_read_b128 v[68:71], v240 offset:32
    ds_read_b128 v[72:75], v240 offset:64
    ds_read_b128 v[76:79], v240 offset:96
    v_lshrrev_b32 v244, 5, v230
    v_and_b32 v245, 15, v230
    v_lshl_add_u32 v244, v244, 6, v245
    v_bfe_u32 v245, v230, 4, 1
    s_add_u32 s31, s25, 152064
    v_lshl_add_u32 v244, v244, 2, s31
    v_lshl_add_u32 v244, v245, 1, v244
    v_mul_u32_u24 v245, 0x8000, v245
    v_lshl_or_b32 v245, v245, 16, v245
    v_lshl_add_u32 v246, v230, 2, s49
    v_lshrrev_b32 v247, 4, v230
    v_and_b32 v241, 15, v230
    v_lshlrev_b32 v241, 4, v241
    v_lshl_add_u32 v247, v247, 16, v241
    v_mfma_f32_32x32x16_bf16 v[160:175], v[116:119], v[216:219], v[160:175]
    s_add_u32 s30, s72, 28
    s_and_b32 s30, s30, 31
    s_and_b32 s31, s30, 28
    s_lshr_b32 s31, s54, s31
    s_and_b32 s31, s31, 15
    s_add_u32 s31, s31, s30
    s_bfe_u32 s30, s30, 0x10001
    s_add_u32 s30, s30, s31
    s_lshl_b32 s30, s30, 14
    s_add_u32 m0, s53, 12288
    s_add_u32 s44, s30, s52
    buffer_load_dwordx4 v234, s[64:67], s44 offen lds
    s_waitcnt lgkmcnt(5)
    v_mfma_f32_32x32x16_bf16 v[176:191], v[56:59], v[192:195], v[176:191]
    v_mfma_f32_32x32x16_bf16 v[160:175], v[120:123], v[192:195], v[160:175]
    s_waitcnt lgkmcnt(4)
    v_mfma_f32_32x32x16_bf16 v[176:191], v[60:63], v[196:199], v[176:191]
    v_mfma_f32_32x32x16_bf16 v[160:175], v[124:127], v[196:199], v[160:175]
    s_nop 11
    s_waitcnt lgkmcnt(0)
    v_pk_fma_f32 v[176:177], v[160:161], v[242:243], v[176:177] op_sel_hi:[1,0,1]
    v_pk_fma_f32 v[178:179], v[162:163], v[242:243], v[178:179] op_sel_hi:[1,0,1]
    v_pk_fma_f32 v[180:181], v[164:165], v[242:243], v[180:181] op_sel_hi:[1,0,1]
    v_pk_fma_f32 v[182:183], v[166:167], v[242:243], v[182:183] op_sel_hi:[1,0,1]
    v_pk_fma_f32 v[184:185], v[168:169], v[242:243], v[184:185] op_sel_hi:[1,0,1]
    v_pk_fma_f32 v[186:187], v[170:171], v[242:243], v[186:187] op_sel_hi:[1,0,1]
    v_pk_fma_f32 v[188:189], v[172:173], v[242:243], v[188:189] op_sel_hi:[1,0,1]
    v_pk_fma_f32 v[190:191], v[174:175], v[242:243], v[190:191] op_sel_hi:[1,0,1]
    v_pk_mul_f32 v[176:177], v[176:177], v[64:65]
    v_pk_mul_f32 v[178:179], v[178:179], v[66:67]
    v_pk_mul_f32 v[180:181], v[180:181], v[68:69]
    v_pk_mul_f32 v[182:183], v[182:183], v[70:71]
    v_pk_mul_f32 v[184:185], v[184:185], v[72:73]
    v_pk_mul_f32 v[186:187], v[186:187], v[74:75]
    v_pk_mul_f32 v[188:189], v[188:189], v[76:77]
    v_pk_mul_f32 v[190:191], v[190:191], v[78:79]
    v_cvt_pk_bf16_f32 v80, v176, v177
    v_cvt_pk_bf16_f32 v81, v178, v179
    v_cvt_pk_bf16_f32 v82, v180, v181
    v_cvt_pk_bf16_f32 v83, v182, v183
    v_cvt_pk_bf16_f32 v84, v184, v185
    v_cvt_pk_bf16_f32 v85, v186, v187
    v_cvt_pk_bf16_f32 v86, v188, v189
    v_cvt_pk_bf16_f32 v87, v190, v191
    ds_swizzle_b32 v88, v80 offset:0x401F
    ds_swizzle_b32 v89, v81 offset:0x401F
    ds_swizzle_b32 v90, v82 offset:0x401F
    ds_swizzle_b32 v91, v83 offset:0x401F
    ds_swizzle_b32 v92, v84 offset:0x401F
    ds_swizzle_b32 v93, v85 offset:0x401F
    ds_swizzle_b32 v94, v86 offset:0x401F
    ds_swizzle_b32 v95, v87 offset:0x401F
    v_mfma_f32_32x32x16_bf16 v[96:111], v[128:131], v[80:83], 0
    v_mfma_f32_32x32x16_bf16 v[96:111], v[132:135], v[84:87], v[96:111]
    s_waitcnt lgkmcnt(0)
    v_xor_b32 v88, v88, v245
    v_xor_b32 v89, v89, v245
    v_xor_b32 v90, v90, v245
    v_xor_b32 v91, v91, v245
    v_xor_b32 v92, v92, v245
    v_xor_b32 v93, v93, v245
    v_xor_b32 v94, v94, v245
    v_xor_b32 v95, v95, v245
    s_nop 1
    v_mfma_f32_32x32x16_bf16 v[96:111], v[136:139], v[88:91], v[96:111]
    v_mfma_f32_32x32x16_bf16 v[96:111], v[140:143], v[92:95], v[96:111]
    s_nop 11
    v_cvt_pk_bf16_f32 v80, v96, v97
    v_cvt_pk_bf16_f32 v81, v98, v99
    v_cvt_pk_bf16_f32 v82, v100, v101
    v_cvt_pk_bf16_f32 v83, v102, v103
    v_cvt_pk_bf16_f32 v84, v104, v105
    v_cvt_pk_bf16_f32 v85, v106, v107
    v_cvt_pk_bf16_f32 v86, v108, v109
    v_cvt_pk_bf16_f32 v87, v110, v111
    ds_write_b16 v244, v80 offset:0
    ds_write_b16_d16_hi v244, v80 offset:64
    ds_write_b16 v244, v81 offset:128
    ds_write_b16_d16_hi v244, v81 offset:192
    ds_write_b16 v244, v82 offset:512
    ds_write_b16_d16_hi v244, v82 offset:576
    ds_write_b16 v244, v83 offset:640
    ds_write_b16_d16_hi v244, v83 offset:704
    ds_write_b16 v244, v84 offset:1024
    ds_write_b16_d16_hi v244, v84 offset:1088
    ds_write_b16 v244, v85 offset:1152
    ds_write_b16_d16_hi v244, v85 offset:1216
    ds_write_b16 v244, v86 offset:1536
    ds_write_b16_d16_hi v244, v86 offset:1600
    ds_write_b16 v244, v87 offset:1664
    ds_write_b16_d16_hi v244, v87 offset:1728
    s_add_u32 s30, s77, 160784
    v_mov_b32 v48, s30
    v_mov_b32 v49, 1
    ds_write_b32 v48, v49
    v_and_b32 v50, 3, v230
    v_lshlrev_b32 v50, 2, v50
    v_add_u32 v50, 160784, v50
    s_mov_b32 s76, 0
L_sp_17:
    ds_read_b32 v51, v50
    s_waitcnt lgkmcnt(0)
    v_cmp_eq_u32 vcc, 0, v51
    s_cbranch_vccz L_spd_18
    s_sleep 1
    s_add_u32 s76, s76, 1
    s_cmp_lt_u32 s76, 1048576
    s_cbranch_scc1 L_sp_17
L_spd_18:
    ds_read_b32 v88, v246 offset:0
    ds_read_b32 v89, v246 offset:2048
    ds_read_b32 v90, v246 offset:4096
    ds_read_b32 v91, v246 offset:6144
    ds_read_b32 v92, v246 offset:256
    ds_read_b32 v93, v246 offset:2304
    ds_read_b32 v94, v246 offset:4352
    ds_read_b32 v95, v246 offset:6400
    s_lshl_b32 s30, s7, 2
    s_add_u32 s30, s30, s4
    s_cmp_lg_u32 s30, 15
    s_cbranch_scc1 L_s0_19
    v_and_b32 v58, 0x1ff, v251
    v_add_u32 v59, 147968, v58
    ds_read_b128 v[60:63], v59
    s_lshl_b32 s30, s6, 12
    s_add_u32 s30, s30, 2097152
    s_mov_b32 exec_hi, 0
    s_waitcnt lgkmcnt(0)
    buffer_store_dwordx4 v[60:63], v58, s[68:71], s30 offen sc1
    s_mov_b32 exec_hi, -1
L_s0_19:
    s_waitcnt lgkmcnt(4)
    buffer_store_dwordx4 v[88:91], v247, s[68:71], s50 offen sc1
    s_waitcnt lgkmcnt(0)
    buffer_store_dwordx4 v[92:95], v247, s[68:71], s35 offen sc1
    s_setprio 0
    s_waitcnt vmcnt(2)
    s_add_u32 s30, s77, 160832
    v_mov_b32 v50, s30
    v_mov_b32 v51, 1
    ds_write_b32 v50, v51
    s_add_u32 s75, s73, 7
    s_cmp_ge_u32 s75, 11
    s_cselect_b32 s30, 11, 0
    s_sub_u32 s75, s75, s30
    s_mul_i32 s30, s75, 5
    s_lshr_b64 s[30:31], s[46:47], s30
    s_and_b32 s30, s30, 31
    s_lshl_b32 s31, s75, 2
    s_cmp_lt_u32 s75, 8
    s_cselect_b32 s31, s31, 0
    s_add_u32 s30, s30, s31
    s_lshl_b32 s30, s30, 14
    s_add_u32 m0, s53, 32768
    s_add_u32 s44, s30, s52
    buffer_load_dwordx4 v234, s[64:67], s44 offen lds
    s_add_u32 s75, s73, 8
    s_cmp_ge_u32 s75, 11
    s_cselect_b32 s30, 11, 0
    s_sub_u32 s75, s75, s30
    s_mul_i32 s30, s75, 5
    s_lshr_b64 s[30:31], s[46:47], s30
    s_and_b32 s30, s30, 31
    s_lshl_b32 s31, s75, 2
    s_cmp_lt_u32 s75, 8
    s_cselect_b32 s31, s31, 0
    s_add_u32 s30, s30, s31
    s_lshl_b32 s30, s30, 14
    s_add_u32 m0, s53, 36864
    s_add_u32 s44, s30, s52
    buffer_load_dwordx4 v234, s[64:67], s44 offen lds
    s_add_u32 s75, s73, 9
    s_cmp_ge_u32 s75, 11
    s_cselect_b32 s30, 11, 0
    s_sub_u32 s75, s75, s30
    s_mul_i32 s30, s75, 5
    s_lshr_b64 s[30:31], s[46:47], s30
    s_and_b32 s30, s30, 31
    s_lshl_b32 s31, s75, 2
    s_cmp_lt_u32 s75, 8
    s_cselect_b32 s31, s31, 0
    s_add_u32 s30, s30, s31
    s_lshl_b32 s30, s30, 14
    s_add_u32 m0, s53, 40960
    s_add_u32 s44, s30, s52
    buffer_load_dwordx4 v234, s[64:67], s44 offen lds
    s_waitcnt vmcnt(3)
    v_mov_b32 v52, 160924
    v_mov_b32 v53, 1
    s_mov_b64 exec, 1
    ds_add_rtn_u32 v54, v52, v53
    s_mov_b64 exec, -1
    s_waitcnt lgkmcnt(0)
    v_readfirstlane_b32 s30, v54
    s_cmp_lg_u32 s30, 3
    s_cbranch_scc1 L_zl_20
    v_lshl_add_u32 v53, v230, 3, s36
    v_mov_b32 v54, s60
    v_mov_b32 v55, s61
    s_mov_b64 exec, 0xffff
    global_store_dwordx2 v53, v[54:55], s[10:11] sc1
    s_mov_b64 exec, -1
L_zl_20:
    s_add_u32 s75, s73, 10
    s_cmp_ge_u32 s75, 11
    s_cselect_b32 s30, 11, 0
    s_sub_u32 s75, s75, s30
    s_mul_i32 s30, s75, 5
    s_lshr_b64 s[30:31], s[46:47], s30
    s_and_b32 s30, s30, 31
    s_lshl_b32 s31, s75, 2
    s_cmp_lt_u32 s75, 8
    s_cselect_b32 s31, s31, 0
    s_add_u32 s30, s30, s31
    s_lshl_b32 s30, s30, 14
    s_add_u32 m0, s53, 45056
    s_add_u32 s44, s30, s52
    buffer_load_dwordx4 v234, s[64:67], s44 offen lds
    v_and_b32 v16, 31, v230
    v_lshl_add_u32 v16, v16, 6, s51
    v_mul_i32_i24 v16, s59, v16
    v_cvt_f32_i32 v17, v16
    v_mul_f32 v17, 0x3a000000, v17
    v_lshrrev_b32 v18, 5, v230
    s_and_b32 s78, s4, 2
    s_lshl_b32 s78, s78, 2
    v_lshl_add_u32 v18, v18, 4, s78
    v_cvt_f32_u32 v18, v18
    v_mul_f32 v18, v18, v17
    v_fmamk_f32 v0, v17, 0x00000000, v18
    v_fmamk_f32 v1, v17, 0x3f800000, v18
    v_fmamk_f32 v2, v17, 0x42000000, v18
    v_fmamk_f32 v3, v17, 0x42040000, v18
    v_fmamk_f32 v4, v17, 0x40000000, v18
    v_fmamk_f32 v5, v17, 0x40400000, v18
    v_fmamk_f32 v6, v17, 0x42080000, v18
    v_fmamk_f32 v7, v17, 0x420c0000, v18
    v_fract_f32 v0, v0
    v_fract_f32 v1, v1
    v_fract_f32 v2, v2
    v_fract_f32 v3, v3
    v_fract_f32 v4, v4
    v_fract_f32 v5, v5
    v_fract_f32 v6, v6
    v_fract_f32 v7, v7
    v_cos_f32 v8, v0
    v_cos_f32 v9, v1
    v_cos_f32 v10, v2
    v_cos_f32 v11, v3
    v_cos_f32 v12, v4
    v_cos_f32 v13, v5
    v_cos_f32 v14, v6
    v_cos_f32 v15, v7
    v_sin_f32 v0, v0
    v_sin_f32 v1, v1
    v_sin_f32 v2, v2
    v_sin_f32 v3, v3
    v_sin_f32 v4, v4
    v_sin_f32 v5, v5
    v_sin_f32 v6, v6
    v_sin_f32 v7, v7
    s_nop 0
    v_cvt_pk_bf16_f32 v144, v8, v0
    v_cvt_pk_bf16_f32 v145, v9, v1
    v_cvt_pk_bf16_f32 v146, v10, v2
    v_cvt_pk_bf16_f32 v147, v11, v3
    v_cvt_pk_bf16_f32 v148, v12, v4
    v_cvt_pk_bf16_f32 v149, v13, v5
    v_cvt_pk_bf16_f32 v150, v14, v6
    v_cvt_pk_bf16_f32 v151, v15, v7
    v_fmamk_f32 v0, v17, 0x40800000, v18
    v_fmamk_f32 v1, v17, 0x40a00000, v18
    v_fmamk_f32 v2, v17, 0x42100000, v18
    v_fmamk_f32 v3, v17, 0x42140000, v18
    v_fmamk_f32 v4, v17, 0x40c00000, v18
    v_fmamk_f32 v5, v17, 0x40e00000, v18
    v_fmamk_f32 v6, v17, 0x42180000, v18
    v_fmamk_f32 v7, v17, 0x421c0000, v18
    v_fract_f32 v0, v0
    v_fract_f32 v1, v1
    v_fract_f32 v2, v2
    v_fract_f32 v3, v3
    v_fract_f32 v4, v4
    v_fract_f32 v5, v5
    v_fract_f32 v6, v6
    v_fract_f32 v7, v7
    v_cos_f32 v8, v0
    v_cos_f32 v9, v1
    v_cos_f32 v10, v2
    v_cos_f32 v11, v3
    v_cos_f32 v12, v4
    v_cos_f32 v13, v5
    v_cos_f32 v14, v6
    v_cos_f32 v15, v7
    v_sin_f32 v0, v0
    v_sin_f32 v1, v1
    v_sin_f32 v2, v2
    v_sin_f32 v3, v3
    v_sin_f32 v4, v4
    v_sin_f32 v5, v5
    v_sin_f32 v6, v6
    v_sin_f32 v7, v7
    s_nop 0
    v_cvt_pk_bf16_f32 v152, v8, v0
    v_cvt_pk_bf16_f32 v153, v9, v1
    v_cvt_pk_bf16_f32 v154, v10, v2
    v_cvt_pk_bf16_f32 v155, v11, v3
    v_cvt_pk_bf16_f32 v156, v12, v4
    v_cvt_pk_bf16_f32 v157, v13, v5
    v_cvt_pk_bf16_f32 v158, v14, v6
    v_cvt_pk_bf16_f32 v159, v15, v7
    s_waitcnt vmcnt(0)
    s_add_u32 s30, s77, 160960
    v_mov_b32 v254, s30
    v_mov_b32 v255, 1
    ds_write_b32 v254, v255
    s_cmp_lg_u32 s4, 0
    s_cbranch_scc1 L_zp_21
    v_and_b32 v56, 0, v230
    v_lshlrev_b32 v56, 2, v56
    v_add_u32 v56, 160920, v56
    s_mov_b32 s76, 0
L_sp_22:
    ds_read_b32 v57, v56
    s_waitcnt lgkmcnt(0)
    v_cmp_eq_u32 vcc, 0, v57
    s_cbranch_vccz L_spd_23
    s_sleep 1
    s_add_u32 s76, s76, 1
    s_cmp_lt_u32 s76, 1048576
    s_cbranch_scc1 L_sp_22
L_spd_23:
    s_mov_b32 s76, 0
L_z1_24:
    global_load_dwordx2 v[60:61], v250, s[10:11] sc1
    global_load_dwordx2 v[62:63], v250, s[10:11] offset:128 sc1
    s_waitcnt vmcnt(0)
    v_cmp_ne_u64 vcc, s[60:61], v[60:61]
    v_cmp_ne_u64 s[78:79], s[60:61], v[62:63]
    s_or_b64 vcc, vcc, s[78:79]
    s_cbranch_scc0 L_z2_25
    s_mov_b64 exec, vcc
    s_sleep 4
    s_add_u32 s76, s76, 1
    s_cmp_lt_u32 s76, 1048576
    s_cbranch_scc1 L_z1_24
L_z2_25:
    s_mov_b64 exec, -1
    v_mov_b32 v48, 160780
    v_mov_b32 v49, 1
    ds_write_b32 v48, v49
L_zp_21:
    v_and_b32 v56, 3, v230
    v_lshlrev_b32 v56, 2, v56
    v_add_u32 v56, 161008, v56
    s_mov_b32 s76, 0
L_sp_26:
    ds_read_b32 v57, v56
    s_waitcnt lgkmcnt(0)
    v_cmp_eq_u32 vcc, 0, v57
    s_cbranch_vccz L_spd_27
    s_sleep 1
    s_add_u32 s76, s76, 1
    s_cmp_lt_u32 s76, 1048576
    s_cbranch_scc1 L_sp_26
L_spd_27:
    s_and_b32 s30, s4, 1
    s_lshl_b32 s30, s30, 13
    s_and_b32 s31, s4, 2
    s_lshl_b32 s31, s31, 11
    s_add_u32 s30, s30, s31
    s_add_u32 s30, s30, 94208
    v_add_u32 v240, s30, v251
    ds_write_b128 v240, v[144:147] offset:0
    ds_write_b128 v240, v[148:151] offset:1024
    ds_write_b128 v240, v[152:155] offset:2048
    ds_write_b128 v240, v[156:159] offset:3072
    s_add_u32 s30, s77, 160976
    v_mov_b32 v254, s30
    v_mov_b32 v255, 1
    ds_write_b32 v254, v255
    s_waitcnt lgkmcnt(0)
    s_endpgm
K_c:
    v_lshlrev_b32 v8, 2, v230
    v_add_u32 v8, 160768, v8
    v_mov_b32 v9, 0
    ds_write_b32 v8, v9
    ds_write_b32 v8, v9 offset:256
    s_and_b32 s48, s4, 1
    s_lshr_b32 s49, s4, 1
    s_lshl_b32 s29, s48, 13
    s_lshl_b32 s30, s48, 5
    s_or_b32 s30, s30, s73
    v_and_b32 v240, 31, v230
    v_lshrrev_b32 v241, 5, v230
    v_bfe_u32 v242, v230, 1, 3
    v_xor_b32 v241, v241, v242
    v_lshlrev_b32 v241, 4, v241
    v_xor_b32 v241, s30, v241
    v_lshl_add_u32 v240, v240, 7, s29
    v_xor_b32 v242, 0, v241
    v_add_u32 v226, v240, v242
    v_xor_b32 v242, 32, v241
    v_add_u32 v227, v240, v242
    v_xor_b32 v242, 64, v241
    v_add_u32 v228, v240, v242
    v_xor_b32 v242, 96, v241
    v_add_u32 v229, v240, v242
    v_lshlrev_b32 v231, 4, v230
    v_lshrrev_b32 v240, 5, v230
    v_bfe_u32 v241, v230, 2, 2
    v_lshl_add_u32 v240, v240, 3, v241
    v_mul_u32_u24 v240, 192, v240
    v_bfe_u32 v241, v230, 4, 1
    v_mul_u32_u24 v241, 6176, v241
    v_and_b32 v242, 3, v230
    v_lshl_add_u32 v240, v242, 3, v240
    s_mul_i32 s30, s49, 96
    s_add_u32 s30, s30, 49152
    s_mul_i32 s31, s48, 3072
    s_add_u32 s77, s30, s31
    v_add3_u32 v222, v240, v241, s77
    s_sub_u32 s77, s30, s31
    s_add_u32 s77, s77, 3072
    v_add3_u32 v223, v240, v241, s77
    v_add_u32 v224, 49408, v222
    v_add_u32 v225, 49408, v223
    v_and_b32 v240, 15, v230
    v_bfe_u32 v241, v230, 4, 1
    v_lshlrev_b32 v241, 2, v241
    v_cmp_eq_u32 vcc, v240, v241
    v_mov_b32 v242, 0x3f803f80
    s_nop 0
    v_cndmask_b32 v200, 0, v242, vcc
    v_cndmask_b32 v201, 0, v242, vcc
    v_cndmask_b32 v202, 0, v242, vcc
    v_cndmask_b32 v203, 0, v242, vcc
    s_lshl_b32 s30, s7, 4
    s_add_u32 s30, s30, 1
    v_and_b32 v0, 15, v230
    v_add_u32 v0, s30, v0
    v_cvt_f32_u32 v0, v0
    v_mul_f32 v0, 0x3b000000, v0
    v_lshrrev_b32 v1, 5, v230
    s_lshl_b32 s30, s4, 4
    v_lshl_add_u32 v1, v1, 3, s30
    v_cvt_f32_u32 v1, v1
    v_bfe_u32 v2, v230, 4, 1
    v_cvt_f32_u32 v2, v2
    v_mul_f32 v2, 0x3e800000, v2
    v_fma_f32 v1, v1, v0, v2
    s_lshl_b32 s30, s4, 13
    s_add_u32 s30, s30, 110912
    v_lshl_add_u32 v3, v230, 4, s30
    s_add_u32 s30, s8, 0
    s_and_b32 s30, s30, 7
    s_lshl_b32 s30, s30, 6
    v_cvt_f32_u32 v2, s30
    v_fma_f32 v2, v2, v0, v1
    v_fract_f32 v2, v2
    v_fmamk_f32 v8, v0, 0x00000000, v2
    v_fmamk_f32 v9, v0, 0x3f800000, v2
    v_fmamk_f32 v10, v0, 0x40000000, v2
    v_fmamk_f32 v11, v0, 0x40400000, v2
    v_fmamk_f32 v12, v0, 0x40800000, v2
    v_fmamk_f32 v13, v0, 0x40a00000, v2
    v_fmamk_f32 v14, v0, 0x40c00000, v2
    v_fmamk_f32 v15, v0, 0x40e00000, v2
    v_cos_f32 v8, v8
    v_cos_f32 v9, v9
    v_cos_f32 v10, v10
    v_cos_f32 v11, v11
    v_cos_f32 v12, v12
    v_cos_f32 v13, v13
    v_cos_f32 v14, v14
    v_cos_f32 v15, v15
    s_nop 0
    v_cvt_pk_bf16_f32 v16, v8, v9
    v_cvt_pk_bf16_f32 v17, v10, v11
    v_cvt_pk_bf16_f32 v18, v12, v13
    v_cvt_pk_bf16_f32 v19, v14, v15
    ds_write_b128 v3, v[16:19] offset:0
    s_add_u32 s30, s8, 1
    s_and_b32 s30, s30, 7
    s_lshl_b32 s30, s30, 6
    v_cvt_f32_u32 v2, s30
    v_fma_f32 v2, v2, v0, v1
    v_fract_f32 v2, v2
    v_fmamk_f32 v8, v0, 0x00000000, v2
    v_fmamk_f32 v9, v0, 0x3f800000, v2
    v_fmamk_f32 v10, v0, 0x40000000, v2
    v_fmamk_f32 v11, v0, 0x40400000, v2
    v_fmamk_f32 v12, v0, 0x40800000, v2
    v_fmamk_f32 v13, v0, 0x40a00000, v2
    v_fmamk_f32 v14, v0, 0x40c00000, v2
    v_fmamk_f32 v15, v0, 0x40e00000, v2
    v_cos_f32 v8, v8
    v_cos_f32 v9, v9
    v_cos_f32 v10, v10
    v_cos_f32 v11, v11
    v_cos_f32 v12, v12
    v_cos_f32 v13, v13
    v_cos_f32 v14, v14
    v_cos_f32 v15, v15
    s_nop 0
    v_cvt_pk_bf16_f32 v20, v8, v9
    v_cvt_pk_bf16_f32 v21, v10, v11
    v_cvt_pk_bf16_f32 v22, v12, v13
    v_cvt_pk_bf16_f32 v23, v14, v15
    ds_write_b128 v3, v[20:23] offset:1024
    s_add_u32 s30, s8, 2
    s_and_b32 s30, s30, 7
    s_lshl_b32 s30, s30, 6
    v_cvt_f32_u32 v2, s30
    v_fma_f32 v2, v2, v0, v1
    v_fract_f32 v2, v2
    v_fmamk_f32 v8, v0, 0x00000000, v2
    v_fmamk_f32 v9, v0, 0x3f800000, v2
    v_fmamk_f32 v10, v0, 0x40000000, v2
    v_fmamk_f32 v11, v0, 0x40400000, v2
    v_fmamk_f32 v12, v0, 0x40800000, v2
    v_fmamk_f32 v13, v0, 0x40a00000, v2
    v_fmamk_f32 v14, v0, 0x40c00000, v2
    v_fmamk_f32 v15, v0, 0x40e00000, v2
    v_cos_f32 v8, v8
    v_cos_f32 v9, v9
    v_cos_f32 v10, v10
    v_cos_f32 v11, v11
    v_cos_f32 v12, v12
    v_cos_f32 v13, v13
    v_cos_f32 v14, v14
    v_cos_f32 v15, v15
    s_nop 0
    v_cvt_pk_bf16_f32 v24, v8, v9
    v_cvt_pk_bf16_f32 v25, v10, v11
    v_cvt_pk_bf16_f32 v26, v12, v13
    v_cvt_pk_bf16_f32 v27, v14, v15
    ds_write_b128 v3, v[24:27] offset:2048
    s_add_u32 s30, s8, 3
    s_and_b32 s30, s30, 7
    s_lshl_b32 s30, s30, 6
    v_cvt_f32_u32 v2, s30
    v_fma_f32 v2, v2, v0, v1
    v_fract_f32 v2, v2
    v_fmamk_f32 v8, v0, 0x00000000, v2
    v_fmamk_f32 v9, v0, 0x3f800000, v2
    v_fmamk_f32 v10, v0, 0x40000000, v2
    v_fmamk_f32 v11, v0, 0x40400000, v2
    v_fmamk_f32 v12, v0, 0x40800000, v2
    v_fmamk_f32 v13, v0, 0x40a00000, v2
    v_fmamk_f32 v14, v0, 0x40c00000, v2
    v_fmamk_f32 v15, v0, 0x40e00000, v2
    v_cos_f32 v8, v8
    v_cos_f32 v9, v9
    v_cos_f32 v10, v10
    v_cos_f32 v11, v11
    v_cos_f32 v12, v12
    v_cos_f32 v13, v13
    v_cos_f32 v14, v14
    v_cos_f32 v15, v15
    s_nop 0
    v_cvt_pk_bf16_f32 v28, v8, v9
    v_cvt_pk_bf16_f32 v29, v10, v11
    v_cvt_pk_bf16_f32 v30, v12, v13
    v_cvt_pk_bf16_f32 v31, v14, v15
    ds_write_b128 v3, v[28:31] offset:3072
    v_and_b32 v0, 31, v230
    v_cvt_f32_u32 v0, v0
    v_mul_f32 v0, 0x3d000000, v0
    v_lshrrev_b32 v1, 5, v230
    s_lshl_b32 s30, s48, 4
    v_lshl_add_u32 v1, v1, 2, s30
    v_cvt_f32_u32 v1, v1
    v_cvt_f32_u32 v2, s49
    v_mul_f32 v2, 0xbe800000, v2
    v_fma_f32 v2, v1, v0, v2
    v_fract_f32 v2, v2
    s_lshl_b32 s30, s4, 10
    s_add_u32 s30, s30, 143680
    v_lshl_add_u32 v4, v230, 4, s30
    v_fmamk_f32 v8, v0, 0x00000000, v2
    v_fmamk_f32 v9, v0, 0x3f800000, v2
    v_fmamk_f32 v10, v0, 0x40000000, v2
    v_fmamk_f32 v11, v0, 0x40400000, v2
    v_fmamk_f32 v12, v0, 0x41000000, v2
    v_fmamk_f32 v13, v0, 0x41100000, v2
    v_fmamk_f32 v14, v0, 0x41200000, v2
    v_fmamk_f32 v15, v0, 0x41300000, v2
    v_cos_f32 v8, v8
    v_cos_f32 v9, v9
    v_cos_f32 v10, v10
    v_cos_f32 v11, v11
    v_cos_f32 v12, v12
    v_cos_f32 v13, v13
    v_cos_f32 v14, v14
    v_cos_f32 v15, v15
    s_nop 0
    v_cvt_pk_bf16_f32 v48, v8, v9
    v_cvt_pk_bf16_f32 v49, v10, v11
    v_cvt_pk_bf16_f32 v50, v12, v13
    v_cvt_pk_bf16_f32 v51, v14, v15
    ds_write_b128 v4, v[48:51] offset:0
    s_waitcnt lgkmcnt(0)
    s_and_b32 s13, s13, 0xffff
    s_or_b32 s30, s2, s4
    s_cmp_lg_u32 s30, 0
    s_cbranch_scc1 L_nw_28
    s_memrealtime s[60:61]
    s_waitcnt lgkmcnt(0)
    s_bitset1_b32 s60, 0
    v_mov_b32 v8, 0
    v_mov_b32 v10, s60
    v_mov_b32 v11, s61
    s_mov_b64 exec, 1
    global_store_dwordx2 v8, v[10:11], s[62:63] sc1
    s_mov_b64 exec, -1
L_nw_28:
    s_mov_b32 s20, s10
    s_and_b32 s21, s11, 0xffff
    s_mov_b32 s22, 5636096
    s_mov_b32 s23, 0x20000
    s_lshl_b32 s34, s6, 1
    s_lshl_b32 s30, s48, 5
    s_add_u32 s34, s34, s30
    s_mul_i32 s34, s34, 86
    s_lshr_b32 s31, s7, 3
    s_mul_i32 s30, s31, 43
    s_add_u32 s34, s34, s30
    s_and_b32 s30, s7, 7
    s_sub_u32 s31, s30, s31
    s_add_u32 s31, s31, 8
    s_cmp_eq_u32 s49, 0
    s_cselect_b32 s31, s30, s31
    s_add_u32 s36, s34, s31
    s_add_u32 s36, s36, 32
    s_lshl_b32 s36, s36, 10
    s_add_u32 s38, s36, 88064
    s_lshl_b32 s30, s30, 2
    s_add_u32 s34, s34, s30
    s_lshl_b32 s30, s49, 1
    s_add_u32 s34, s34, s30
    s_lshl_b32 s34, s34, 10
    s_add_u32 s33, s34, 88064
    s_lshl_b32 s35, s6, 5
    s_add_u32 s35, s35, s7
    s_lshl_b32 s35, s35, 7
    s_add_u32 s35, s35, 8454144
    s_lshl_b32 s30, s48, 10
    s_add_u32 s30, s30, 161280
    v_and_b32 v240, 31, v230
    v_lshl_add_u32 v232, v240, 4, s30
    v_mov_b32 v238, 160912
    v_mov_b32 v190, 0
    v_mov_b32 v191, 0
    v_mov_b32 v194, 0
    v_mov_b32 v195, 0
    v_mov_b32 v198, 0
    v_mov_b32 v199, 0
    s_mul_i32 s30, s49, 1536
    s_add_u32 s30, s30, 148480
    v_and_b32 v240, 31, v230
    v_lshl_add_u32 v234, v240, 4, s30
    v_lshrrev_b32 v241, 5, v230
    v_lshl_add_u32 v234, v241, 3, v234
    s_lshl_b32 s30, s48, 10
    s_lshl_b32 s31, s49, 9
    s_add_u32 s30, s30, s31
    s_add_u32 s30, s30, 161280
    v_lshl_add_u32 v233, v240, 4, s30
    v_mov_b32 v184, 0
    s_and_b32 s30, s2, 7
    s_lshr_b32 s31, s2, 3
    s_and_b32 s77, s31, 3
    s_lshl_b32 s56, s30, 2
    s_add_u32 s56, s56, s77
    s_lshr_b32 s57, s31, 2
    s_lshl_b32 s77, s77, 1
    s_add_u32 s77, s77, s57
    s_and_b32 s77, s77, 7
    s_lshl_b32 s72, s77, 2
    s_mul_i32 s73, s77, 11
    s_lshr_b32 s73, s73, 3
    s_lshr_b32 s58, s4, 1
    s_mul_i32 s58, s58, 43
    s_and_b32 s65, s65, 0xffff
    s_mov_b32 s66, 1409024
    s_mov_b32 s67, 0x20000
    s_cmp_lt_u32 s4, 2
    s_cselect_b32 s54, 0xa9876420, 0
    s_cselect_b32 s46, 0xd4941882, 0
    s_cselect_b32 s47, 0x456562, 0
    s_cselect_b32 s54, s54, 0xa9875310
    s_cselect_b32 s46, s46, 0xd4939462
    s_cselect_b32 s47, s47, 0x5a0a62
    s_lshl_b32 s52, s58, 14
    s_lshl_b32 s31, s57, 7
    s_add_u32 s52, s52, s31
    s_and_b32 s31, s4, 1
    s_lshl_b32 s31, s31, 13
    s_add_u32 s52, s52, s31
    s_lshl_b32 s53, s4, 10
    v_lshrrev_b32 v240, 3, v230
    v_bfe_u32 v241, v230, 4, 1
    v_lshlrev_b32 v241, 2, v241
    v_and_b32 v242, 7, v230
    v_xor_b32 v241, v241, v242
    v_lshlrev_b32 v241, 4, v241
    v_lshl_add_u32 v235, v240, 10, v241
    s_and_b32 s69, s69, 0xffff
    s_mov_b32 s70, 0x200000
    s_mov_b32 s71, 0x20000
    s_lshl_b32 s30, s48, 5
    s_add_u32 s30, s30, s56
    s_mul_i32 s26, s30, 86
    s_add_u32 s26, s26, s58
    s_lshl_b32 s26, s26, 10
    v_add_u32 v239, s26, v231
    s_lshl_b32 s27, s30, 10
    s_lshl_b32 s31, s57, 7
    s_add_u32 s27, s27, s31
    s_lshl_b32 s37, s49, 6
    s_add_u32 s27, s27, s37
    s_lshr_b32 s50, s56, 1
    s_lshl_b32 s50, s50, 12
    s_add_u32 s50, s50, 8454144
    v_and_b32 v240, 15, v230
    v_lshl_add_u32 v220, v240, 7, s50
    v_lshrrev_b32 v240, 5, v230
    v_bfe_u32 v241, v230, 2, 2
    v_lshl_add_u32 v240, v240, 2, v241
    v_lshlrev_b32 v240, 7, v240
    v_and_b32 v242, 1, v230
    v_lshl_add_u32 v240, v242, 5, v240
    v_bfe_u32 v242, v230, 4, 1
    v_lshl_add_u32 v240, v242, 4, v240
    v_bfe_u32 v242, v230, 1, 1
    v_lshl_add_u32 v240, v242, 3, v240
    v_bfe_u32 v242, v230, 3, 1
    v_lshl_add_u32 v240, v242, 6, v240
    v_xor_b32 v240, s37, v240
    s_lshl_b32 s30, s49, 11
    v_add_u32 v248, s30, v240
    v_xor_b32 v249, 64, v248
    v_add_u32 v250, 0xc000, v248
    v_add_u32 v251, 0xc000, v249
    v_add_u32 v252, 0x18000, v248
    v_add_u32 v253, 0x18000, v249
    v_and_b32 v240, 31, v230
    v_lshrrev_b32 v241, 5, v230
    v_lshlrev_b32 v240, 16, v240
    v_lshl_add_u32 v221, v241, 5, v240
    s_add_u32 s30, s72, 29
    s_and_b32 s30, s30, 31
    s_and_b32 s31, s30, 28
    s_lshr_b32 s31, s54, s31
    s_and_b32 s31, s31, 15
    s_add_u32 s31, s31, s30
    s_bfe_u32 s30, s30, 0x10001
    s_add_u32 s30, s30, s31
    s_lshl_b32 s30, s30, 14
    s_add_u32 s5, s30, s52
    s_add_u32 s30, s72, 30
    s_and_b32 s30, s30, 31
    s_and_b32 s31, s30, 28
    s_lshr_b32 s31, s54, s31
    s_and_b32 s31, s31, 15
    s_add_u32 s31, s31, s30
    s_bfe_u32 s30, s30, 0x10001
    s_add_u32 s30, s30, s31
    s_lshl_b32 s30, s30, 14
    s_add_u32 s8, s30, s52
    s_add_u32 s30, s72, 31
    s_and_b32 s30, s30, 31
    s_and_b32 s31, s30, 28
    s_lshr_b32 s31, s54, s31
    s_and_b32 s31, s31, 15
    s_add_u32 s31, s31, s30
    s_bfe_u32 s30, s30, 0x10001
    s_add_u32 s30, s30, s31
    s_lshl_b32 s30, s30, 14
    s_add_u32 s9, s30, s52
    s_add_u32 s75, s73, 3
    s_cmp_ge_u32 s75, 11
    s_cselect_b32 s30, 11, 0
    s_sub_u32 s75, s75, s30
    s_mul_i32 s30, s75, 5
    s_lshr_b64 s[30:31], s[46:47], s30
    s_and_b32 s30, s30, 31
    s_lshl_b32 s31, s75, 2
    s_cmp_lt_u32 s75, 8
    s_cselect_b32 s31, s31, 0
    s_add_u32 s30, s30, s31
    s_lshl_b32 s30, s30, 14
    s_add_u32 s39, s30, s52
    s_add_u32 s75, s73, 4
    s_cmp_ge_u32 s75, 11
    s_cselect_b32 s30, 11, 0
    s_sub_u32 s75, s75, s30
    s_mul_i32 s30, s75, 5
    s_lshr_b64 s[30:31], s[46:47], s30
    s_and_b32 s30, s30, 31
    s_lshl_b32 s31, s75, 2
    s_cmp_lt_u32 s75, 8
    s_cselect_b32 s31, s31, 0
    s_add_u32 s30, s30, s31
    s_lshl_b32 s30, s30, 14
    s_add_u32 s40, s30, s52
    s_add_u32 s75, s73, 5
    s_cmp_ge_u32 s75, 11
    s_cselect_b32 s30, 11, 0
    s_sub_u32 s75, s75, s30
    s_mul_i32 s30, s75, 5
    s_lshr_b64 s[30:31], s[46:47], s30
    s_and_b32 s30, s30, 31
    s_lshl_b32 s31, s75, 2
    s_cmp_lt_u32 s75, 8
    s_cselect_b32 s31, s31, 0
    s_add_u32 s30, s30, s31
    s_lshl_b32 s30, s30, 14
    s_add_u32 s41, s30, s52
    s_add_u32 s75, s73, 6
    s_cmp_ge_u32 s75, 11
    s_cselect_b32 s30, 11, 0
    s_sub_u32 s75, s75, s30
    s_mul_i32 s30, s75, 5
    s_lshr_b64 s[30:31], s[46:47], s30
    s_and_b32 s30, s30, 31
    s_lshl_b32 s31, s75, 2
    s_cmp_lt_u32 s75, 8
    s_cselect_b32 s31, s31, 0
    s_add_u32 s30, s30, s31
    s_lshl_b32 s30, s30, 14
    s_add_u32 s42, s30, s52
    s_add_u32 s16, s10, 6291456
    s_addc_u32 s17, s11, 0
    s_and_b32 s17, s17, 0xffff
    s_mov_b32 s18, 2162688
    s_mov_b32 s19, 0x20000
    s_lshl_b32 s30, s57, 6
    s_lshl_b32 s31, s49, 5
    s_add_u32 s30, s30, s31
    s_sub_u32 s31, 511, s30
    s_sub_u32 s30, s30, 1
    s_sub_u32 s74, 32, s56
    s_and_b32 s74, s74, 31
    s_cmp_lt_u32 s57, 4
    s_cselect_b32 s75, 1, -1
    s_cselect_b32 s30, s30, s31
    s_cselect_b32 s74, s56, s74
    s_lshl_b32 s74, s74, 16
    v_and_b32 v240, 3, v230
    v_bfe_u32 v241, v230, 2, 1
    v_lshl_add_u32 v240, v241, 4, v240
    v_bfe_u32 v241, v230, 3, 2
    v_lshl_add_u32 v240, v241, 2, v240
    v_mul_i32_i24 v240, s75, v240
    v_add_u32 v240, s30, v240
    v_lshrrev_b32 v241, 5, v230
    v_cmp_gt_i32 vcc, 0, v240
    v_lshlrev_b32 v242, 11, v241
    v_add_lshl_u32 v254, v240, v242, 4
    s_mul_i32 s31, s56, 65520
    s_sub_u32 s31, 2097152, s31
    v_lshl_add_u32 v242, v241, 15, s31
    v_cndmask_b32 v254, v254, v242, vcc
    s_lshl_b32 s30, s48, 13
    s_add_u32 s30, s30, 94208
    v_add_u32 v255, s30, v231
    s_andn2_b32 s30, s49, s25
    s_cmp_eq_u32 s30, 0
    s_cbranch_scc1 K_c3
    s_lshl_b32 s30, s2, 2
    s_add_u32 s30, s30, s4
    s_mul_i32 s30, s30, 1408
    v_lshlrev_b32 v246, 7, v230
    s_mov_b64 exec, 0x7ff
    buffer_load_dword v247, v246, s[64:67], s30 offen
    s_mov_b64 exec, -1
    s_setprio 3
    s_barrier
    ds_read_b128 v[144:147], v226 offset:0
    ds_read_b64_tr_b16 v[96:97], v222 offset:0
    ds_read_b64_tr_b16 v[98:99], v222 offset:768
    ds_read_b128 v[148:151], v226 offset:4096
    ds_read_b64_tr_b16 v[100:101], v222 offset:32
    ds_read_b64_tr_b16 v[102:103], v222 offset:800
    ds_read_b128 v[152:155], v227 offset:0
    ds_read_b64_tr_b16 v[108:109], v223 offset:0
    ds_read_b64_tr_b16 v[110:111], v223 offset:768
    ds_read_b128 v[156:159], v227 offset:4096
    ds_read_b64_tr_b16 v[112:113], v223 offset:32
    ds_read_b64_tr_b16 v[114:115], v223 offset:800
    s_waitcnt lgkmcnt(2)
    s_barrier
    v_mfma_f32_32x32x16_bf16 v[0:15], v[96:99], v[144:147], 0
    ds_read_b128 v[160:163], v228 offset:0
    ds_read_b64_tr_b16 v[120:121], v222 offset:12352
    v_mfma_f32_32x32x16_bf16 v[48:63], v[96:99], v[148:151], 0
    ds_read_b64_tr_b16 v[122:123], v222 offset:13120
    ds_read_b128 v[164:167], v228 offset:4096
    v_mfma_f32_16x16x32_bf16 v[176:179], v[200:203], v[96:99], 0
    v_mfma_f32_32x32x16_bf16 v[16:31], v[100:103], v[144:147], 0
    ds_read_b64_tr_b16 v[124:125], v222 offset:12384
    ds_read_b64_tr_b16 v[126:127], v222 offset:13152
    v_mfma_f32_32x32x16_bf16 v[64:79], v[100:103], v[148:151], 0
    ds_read_b128 v[168:171], v229 offset:0
    ds_read_b64_tr_b16 v[132:133], v223 offset:12352
    v_mfma_f32_16x16x32_bf16 v[180:183], v[200:203], v[100:103], 0
    v_mfma_f32_32x32x16_bf16 v[0:15], v[108:111], v[152:155], v[0:15]
    ds_read_b64_tr_b16 v[134:135], v223 offset:13120
    ds_read_b128 v[172:175], v229 offset:4096
    v_mfma_f32_32x32x16_bf16 v[48:63], v[108:111], v[156:159], v[48:63]
    ds_read_b64_tr_b16 v[136:137], v223 offset:12384
    ds_read_b64_tr_b16 v[138:139], v223 offset:13152
    s_waitcnt lgkmcnt(12)
    v_mfma_f32_32x32x16_bf16 v[16:31], v[112:115], v[152:155], v[16:31]
    v_mfma_f32_32x32x16_bf16 v[64:79], v[112:115], v[156:159], v[64:79]
    s_nop 3
    s_mov_b32 exec_hi, 0
    ds_write_b32 v233, v176 offset:0
    ds_write_b32 v233, v180 offset:4
    ds_write_b32 v233, v184 offset:8
    s_mov_b32 exec_hi, -1
    s_waitcnt lgkmcnt(0)
    s_barrier
    v_mfma_f32_32x32x16_bf16 v[0:15], v[120:123], v[160:163], v[0:15]
    ds_read_b128 v[144:147], v226 offset:16384
    ds_read_b64_tr_b16 v[96:97], v222 offset:24704
    v_mfma_f32_32x32x16_bf16 v[48:63], v[120:123], v[164:167], v[48:63]
    ds_read_b64_tr_b16 v[98:99], v222 offset:25472
    ds_read_b128 v[148:151], v226 offset:20480
    v_mfma_f32_32x32x16_bf16 v[16:31], v[124:127], v[160:163], v[16:31]
    ds_read_b64_tr_b16 v[100:101], v222 offset:24736
    ds_read_b64_tr_b16 v[102:103], v222 offset:25504
    v_mfma_f32_32x32x16_bf16 v[64:79], v[124:127], v[164:167], v[64:79]
    ds_read_b128 v[152:155], v227 offset:16384
    ds_read_b64_tr_b16 v[108:109], v223 offset:24704
    v_mfma_f32_32x32x16_bf16 v[0:15], v[132:135], v[168:171], v[0:15]
    ds_read_b64_tr_b16 v[110:111], v223 offset:25472
    ds_read_b128 v[156:159], v227 offset:20480
    v_mfma_f32_32x32x16_bf16 v[48:63], v[132:135], v[172:175], v[48:63]
    ds_read_b64_tr_b16 v[112:113], v223 offset:24736
    ds_read_b64_tr_b16 v[114:115], v223 offset:25504
    v_mfma_f32_32x32x16_bf16 v[16:31], v[136:139], v[168:171], v[16:31]
    v_mfma_f32_32x32x16_bf16 v[64:79], v[136:139], v[172:175], v[64:79]
    s_waitcnt lgkmcnt(9)
    v_mfma_f32_32x32x16_bf16 v[0:15], v[96:99], v[144:147], v[0:15]
    ds_read_b128 v[160:163], v228 offset:16384
    ds_read_b64_tr_b16 v[120:121], v222 offset:37056
    s_waitcnt lgkmcnt(10)
    v_mfma_f32_32x32x16_bf16 v[48:63], v[96:99], v[148:151], v[48:63]
    ds_read_b64_tr_b16 v[122:123], v222 offset:37824
    ds_read_b128 v[164:167], v228 offset:20480
    s_waitcnt lgkmcnt(10)
    v_mfma_f32_32x32x16_bf16 v[16:31], v[100:103], v[144:147], v[16:31]
    ds_read_b64_tr_b16 v[124:125], v222 offset:37088
    ds_read_b64_tr_b16 v[126:127], v222 offset:37856
    v_mfma_f32_32x32x16_bf16 v[64:79], v[100:103], v[148:151], v[64:79]
    ds_read_b128 v[168:171], v229 offset:16384
    ds_read_b64_tr_b16 v[132:133], v223 offset:37056
    s_waitcnt lgkmcnt(11)
    v_mfma_f32_32x32x16_bf16 v[0:15], v[108:111], v[152:155], v[0:15]
    ds_read_b64_tr_b16 v[134:135], v223 offset:37824
    ds_read_b128 v[172:175], v229 offset:20480
    s_waitcnt lgkmcnt(12)
    v_mfma_f32_32x32x16_bf16 v[48:63], v[108:111], v[156:159], v[48:63]
    ds_read_b64_tr_b16 v[136:137], v223 offset:37088
    ds_read_b64_tr_b16 v[138:139], v223 offset:37856
    s_waitcnt lgkmcnt(12)
    v_mfma_f32_32x32x16_bf16 v[16:31], v[112:115], v[152:155], v[16:31]
    v_mfma_f32_32x32x16_bf16 v[64:79], v[112:115], v[156:159], v[64:79]
    s_waitcnt lgkmcnt(2)
    s_barrier
    v_mfma_f32_32x32x16_bf16 v[0:15], v[120:123], v[160:163], v[0:15]
    ds_read_b128 v[144:147], v226 offset:32768
    ds_read_b64_tr_b16 v[96:97], v224 offset:0
    v_mfma_f32_32x32x16_bf16 v[48:63], v[120:123], v[164:167], v[48:63]
    ds_read_b64_tr_b16 v[98:99], v224 offset:768
    ds_read_b128 v[148:151], v226 offset:36864
    v_mfma_f32_32x32x16_bf16 v[16:31], v[124:127], v[160:163], v[16:31]
    ds_read_b64_tr_b16 v[100:101], v224 offset:32
    ds_read_b64_tr_b16 v[102:103], v224 offset:800
    v_mfma_f32_32x32x16_bf16 v[64:79], v[124:127], v[164:167], v[64:79]
    ds_read_b128 v[152:155], v227 offset:32768
    ds_read_b64_tr_b16 v[108:109], v225 offset:0
    v_mfma_f32_32x32x16_bf16 v[0:15], v[132:135], v[168:171], v[0:15]
    ds_read_b64_tr_b16 v[110:111], v225 offset:768
    ds_read_b128 v[156:159], v227 offset:36864
    v_mfma_f32_32x32x16_bf16 v[48:63], v[132:135], v[172:175], v[48:63]
    ds_read_b64_tr_b16 v[112:113], v225 offset:32
    ds_read_b64_tr_b16 v[114:115], v225 offset:800
    s_waitcnt lgkmcnt(12)
    v_mfma_f32_32x32x16_bf16 v[16:31], v[136:139], v[168:171], v[16:31]
    v_mfma_f32_32x32x16_bf16 v[64:79], v[136:139], v[172:175], v[64:79]
    s_waitcnt lgkmcnt(9)
    v_mfma_f32_32x32x16_bf16 v[0:15], v[96:99], v[144:147], v[0:15]
    ds_read_b128 v[160:163], v228 offset:32768
    ds_read_b64_tr_b16 v[120:121], v224 offset:12352
    s_waitcnt lgkmcnt(10)
    v_mfma_f32_32x32x16_bf16 v[48:63], v[96:99], v[148:151], v[48:63]
    ds_read_b64_tr_b16 v[122:123], v224 offset:13120
    ds_read_b128 v[164:167], v228 offset:36864
    s_waitcnt lgkmcnt(10)
    v_mfma_f32_32x32x16_bf16 v[16:31], v[100:103], v[144:147], v[16:31]
    ds_read_b64_tr_b16 v[124:125], v224 offset:12384
    ds_read_b64_tr_b16 v[126:127], v224 offset:13152
    v_mfma_f32_32x32x16_bf16 v[64:79], v[100:103], v[148:151], v[64:79]
    ds_read_b128 v[168:171], v229 offset:32768
    ds_read_b64_tr_b16 v[132:133], v225 offset:12352
    s_waitcnt lgkmcnt(11)
    v_mfma_f32_32x32x16_bf16 v[0:15], v[108:111], v[152:155], v[0:15]
    ds_read_b64_tr_b16 v[134:135], v225 offset:13120
    ds_read_b128 v[172:175], v229 offset:36864
    s_waitcnt lgkmcnt(12)
    v_mfma_f32_32x32x16_bf16 v[48:63], v[108:111], v[156:159], v[48:63]
    ds_read_b64_tr_b16 v[136:137], v225 offset:12384
    ds_read_b64_tr_b16 v[138:139], v225 offset:13152
    s_waitcnt lgkmcnt(12)
    v_mfma_f32_32x32x16_bf16 v[16:31], v[112:115], v[152:155], v[16:31]
    v_mfma_f32_32x32x16_bf16 v[64:79], v[112:115], v[156:159], v[64:79]
    s_waitcnt lgkmcnt(2)
    s_barrier
    v_mfma_f32_32x32x16_bf16 v[0:15], v[120:123], v[160:163], v[0:15]
    ds_read_b128 v[144:147], v226 offset:0
    ds_read_b64_tr_b16 v[96:97], v224 offset:24704
    v_mfma_f32_32x32x16_bf16 v[48:63], v[120:123], v[164:167], v[48:63]
    ds_read_b64_tr_b16 v[98:99], v224 offset:25472
    ds_read_b128 v[148:151], v226 offset:4096
    v_mfma_f32_32x32x16_bf16 v[16:31], v[124:127], v[160:163], v[16:31]
    ds_read_b64_tr_b16 v[100:101], v224 offset:24736
    ds_read_b64_tr_b16 v[102:103], v224 offset:25504
    v_mfma_f32_32x32x16_bf16 v[64:79], v[124:127], v[164:167], v[64:79]
    ds_read_b128 v[152:155], v227 offset:0
    ds_read_b64_tr_b16 v[108:109], v225 offset:24704
    v_mfma_f32_32x32x16_bf16 v[0:15], v[132:135], v[168:171], v[0:15]
    ds_read_b64_tr_b16 v[110:111], v225 offset:25472
    ds_read_b128 v[156:159], v227 offset:4096
    v_mfma_f32_32x32x16_bf16 v[48:63], v[132:135], v[172:175], v[48:63]
    ds_read_b64_tr_b16 v[112:113], v225 offset:24736
    ds_read_b64_tr_b16 v[114:115], v225 offset:25504
    s_waitcnt lgkmcnt(12)
    v_mfma_f32_32x32x16_bf16 v[16:31], v[136:139], v[168:171], v[16:31]
    v_mfma_f32_32x32x16_bf16 v[64:79], v[136:139], v[172:175], v[64:79]
    s_waitcnt lgkmcnt(9)
    v_mfma_f32_32x32x16_bf16 v[0:15], v[96:99], v[144:147], v[0:15]
    ds_read_b128 v[160:163], v228 offset:0
    ds_read_b64_tr_b16 v[120:121], v224 offset:37056
    s_waitcnt lgkmcnt(10)
    v_mfma_f32_32x32x16_bf16 v[48:63], v[96:99], v[148:151], v[48:63]
    ds_read_b64_tr_b16 v[122:123], v224 offset:37824
    ds_read_b128 v[164:167], v228 offset:4096
    s_waitcnt lgkmcnt(10)
    v_mfma_f32_32x32x16_bf16 v[16:31], v[100:103], v[144:147], v[16:31]
    ds_read_b64_tr_b16 v[124:125], v224 offset:37088
    ds_read_b64_tr_b16 v[126:127], v224 offset:37856
    v_mfma_f32_32x32x16_bf16 v[64:79], v[100:103], v[148:151], v[64:79]
    ds_read_b128 v[168:171], v229 offset:0
    ds_read_b64_tr_b16 v[132:133], v225 offset:37056
    s_waitcnt lgkmcnt(11)
    v_mfma_f32_32x32x16_bf16 v[0:15], v[108:111], v[152:155], v[0:15]
    ds_read_b64_tr_b16 v[134:135], v225 offset:37824
    ds_read_b128 v[172:175], v229 offset:4096
    s_waitcnt lgkmcnt(12)
    v_mfma_f32_32x32x16_bf16 v[48:63], v[108:111], v[156:159], v[48:63]
    ds_read_b64_tr_b16 v[136:137], v225 offset:37088
    ds_read_b64_tr_b16 v[138:139], v225 offset:37856
    s_waitcnt lgkmcnt(12)
    v_mfma_f32_32x32x16_bf16 v[16:31], v[112:115], v[152:155], v[16:31]
    v_mfma_f32_32x32x16_bf16 v[64:79], v[112:115], v[156:159], v[64:79]
    s_waitcnt lgkmcnt(2)
    s_barrier
    v_mfma_f32_32x32x16_bf16 v[0:15], v[120:123], v[160:163], v[0:15]
    ds_read_b128 v[144:147], v226 offset:16384
    ds_read_b64_tr_b16 v[96:97], v222 offset:0
    v_mfma_f32_32x32x16_bf16 v[48:63], v[120:123], v[164:167], v[48:63]
    ds_read_b64_tr_b16 v[98:99], v222 offset:768
    ds_read_b128 v[148:151], v226 offset:20480
    v_mfma_f32_32x32x16_bf16 v[16:31], v[124:127], v[160:163], v[16:31]
    ds_read_b64_tr_b16 v[100:101], v222 offset:32
    ds_read_b64_tr_b16 v[102:103], v222 offset:800
    v_mfma_f32_32x32x16_bf16 v[64:79], v[124:127], v[164:167], v[64:79]
    ds_read_b128 v[152:155], v227 offset:16384
    ds_read_b64_tr_b16 v[108:109], v223 offset:0
    v_mfma_f32_32x32x16_bf16 v[0:15], v[132:135], v[168:171], v[0:15]
    ds_read_b64_tr_b16 v[110:111], v223 offset:768
    ds_read_b128 v[156:159], v227 offset:20480
    v_mfma_f32_32x32x16_bf16 v[48:63], v[132:135], v[172:175], v[48:63]
    ds_read_b64_tr_b16 v[112:113], v223 offset:32
    ds_read_b64_tr_b16 v[114:115], v223 offset:800
    s_waitcnt lgkmcnt(12)
    v_mfma_f32_32x32x16_bf16 v[16:31], v[136:139], v[168:171], v[16:31]
    v_mfma_f32_32x32x16_bf16 v[64:79], v[136:139], v[172:175], v[64:79]
    s_waitcnt lgkmcnt(9)
    v_mfma_f32_32x32x16_bf16 v[0:15], v[96:99], v[144:147], v[0:15]
    ds_read_b128 v[160:163], v228 offset:16384
    ds_read_b64_tr_b16 v[120:121], v222 offset:12352
    s_waitcnt lgkmcnt(10)
    v_mfma_f32_32x32x16_bf16 v[48:63], v[96:99], v[148:151], v[48:63]
    ds_read_b64_tr_b16 v[122:123], v222 offset:13120
    ds_read_b128 v[164:167], v228 offset:20480
    s_waitcnt lgkmcnt(10)
    v_mfma_f32_32x32x16_bf16 v[16:31], v[100:103], v[144:147], v[16:31]
    ds_read_b64_tr_b16 v[124:125], v222 offset:12384
    ds_read_b64_tr_b16 v[126:127], v222 offset:13152
    v_mfma_f32_32x32x16_bf16 v[64:79], v[100:103], v[148:151], v[64:79]
    ds_read_b128 v[168:171], v229 offset:16384
    ds_read_b64_tr_b16 v[132:133], v223 offset:12352
    s_waitcnt lgkmcnt(11)
    v_mfma_f32_32x32x16_bf16 v[0:15], v[108:111], v[152:155], v[0:15]
    ds_read_b64_tr_b16 v[134:135], v223 offset:13120
    ds_read_b128 v[172:175], v229 offset:20480
    s_waitcnt lgkmcnt(12)
    v_mfma_f32_32x32x16_bf16 v[48:63], v[108:111], v[156:159], v[48:63]
    ds_read_b64_tr_b16 v[136:137], v223 offset:12384
    ds_read_b64_tr_b16 v[138:139], v223 offset:13152
    s_waitcnt lgkmcnt(12)
    v_mfma_f32_32x32x16_bf16 v[16:31], v[112:115], v[152:155], v[16:31]
    v_mfma_f32_32x32x16_bf16 v[64:79], v[112:115], v[156:159], v[64:79]
    s_waitcnt lgkmcnt(2)
    s_barrier
    v_mfma_f32_32x32x16_bf16 v[0:15], v[120:123], v[160:163], v[0:15]
    ds_read_b128 v[144:147], v226 offset:32768
    ds_read_b64_tr_b16 v[96:97], v222 offset:24704
    v_mfma_f32_32x32x16_bf16 v[48:63], v[120:123], v[164:167], v[48:63]
    ds_read_b64_tr_b16 v[98:99], v222 offset:25472
    ds_read_b128 v[148:151], v226 offset:36864
    v_mfma_f32_32x32x16_bf16 v[16:31], v[124:127], v[160:163], v[16:31]
    ds_read_b64_tr_b16 v[100:101], v222 offset:24736
    ds_read_b64_tr_b16 v[102:103], v222 offset:25504
    v_mfma_f32_32x32x16_bf16 v[64:79], v[124:127], v[164:167], v[64:79]
    ds_read_b128 v[152:155], v227 offset:32768
    ds_read_b64_tr_b16 v[108:109], v223 offset:24704
    v_mfma_f32_32x32x16_bf16 v[0:15], v[132:135], v[168:171], v[0:15]
    ds_read_b64_tr_b16 v[110:111], v223 offset:25472
    ds_read_b128 v[156:159], v227 offset:36864
    v_mfma_f32_32x32x16_bf16 v[48:63], v[132:135], v[172:175], v[48:63]
    ds_read_b64_tr_b16 v[112:113], v223 offset:24736
    ds_read_b64_tr_b16 v[114:115], v223 offset:25504
    s_waitcnt lgkmcnt(12)
    v_mfma_f32_32x32x16_bf16 v[16:31], v[136:139], v[168:171], v[16:31]
    v_mfma_f32_32x32x16_bf16 v[64:79], v[136:139], v[172:175], v[64:79]
    s_waitcnt lgkmcnt(9)
    v_mfma_f32_32x32x16_bf16 v[0:15], v[96:99], v[144:147], v[0:15]
    ds_read_b128 v[160:163], v228 offset:32768
    ds_read_b64_tr_b16 v[120:121], v222 offset:37056
    s_waitcnt lgkmcnt(10)
    v_mfma_f32_32x32x16_bf16 v[48:63], v[96:99], v[148:151], v[48:63]
    ds_read_b64_tr_b16 v[122:123], v222 offset:37824
    ds_read_b128 v[164:167], v228 offset:36864
    s_waitcnt lgkmcnt(10)
    v_mfma_f32_32x32x16_bf16 v[16:31], v[100:103], v[144:147], v[16:31]
    ds_read_b64_tr_b16 v[124:125], v222 offset:37088
    ds_read_b64_tr_b16 v[126:127], v222 offset:37856
    v_mfma_f32_32x32x16_bf16 v[64:79], v[100:103], v[148:151], v[64:79]
    ds_read_b128 v[168:171], v229 offset:32768
    ds_read_b64_tr_b16 v[132:133], v223 offset:37056
    s_waitcnt lgkmcnt(11)
    v_mfma_f32_32x32x16_bf16 v[0:15], v[108:111], v[152:155], v[0:15]
    ds_read_b64_tr_b16 v[134:135], v223 offset:37824
    ds_read_b128 v[172:175], v229 offset:36864
    s_waitcnt lgkmcnt(12)
    v_mfma_f32_32x32x16_bf16 v[48:63], v[108:111], v[156:159], v[48:63]
    ds_read_b64_tr_b16 v[136:137], v223 offset:37088
    ds_read_b64_tr_b16 v[138:139], v223 offset:37856
    s_waitcnt lgkmcnt(12)
    v_mfma_f32_32x32x16_bf16 v[16:31], v[112:115], v[152:155], v[16:31]
    v_mfma_f32_32x32x16_bf16 v[64:79], v[112:115], v[156:159], v[64:79]
    s_waitcnt lgkmcnt(2)
    s_barrier
    s_waitcnt vmcnt(0)
    v_mfma_f32_32x32x16_bf16 v[0:15], v[120:123], v[160:163], v[0:15]
    ds_read_b128 v[144:147], v226 offset:0
    ds_read_b64_tr_b16 v[96:97], v224 offset:0
    v_mfma_f32_32x32x16_bf16 v[48:63], v[120:123], v[164:167], v[48:63]
    ds_read_b64_tr_b16 v[98:99], v224 offset:768
    ds_read_b128 v[148:151], v226 offset:4096
    v_mfma_f32_32x32x16_bf16 v[16:31], v[124:127], v[160:163], v[16:31]
    ds_read_b64_tr_b16 v[100:101], v224 offset:32
    ds_read_b64_tr_b16 v[102:103], v224 offset:800
    v_mfma_f32_32x32x16_bf16 v[64:79], v[124:127], v[164:167], v[64:79]
    ds_read_b128 v[152:155], v227 offset:0
    ds_read_b64_tr_b16 v[108:109], v225 offset:0
    v_mfma_f32_32x32x16_bf16 v[0:15], v[132:135], v[168:171], v[0:15]
    ds_read_b64_tr_b16 v[110:111], v225 offset:768
    ds_read_b128 v[156:159], v227 offset:4096
    v_mfma_f32_32x32x16_bf16 v[48:63], v[132:135], v[172:175], v[48:63]
    ds_read_b64_tr_b16 v[112:113], v225 offset:32
    ds_read_b64_tr_b16 v[114:115], v225 offset:800
    s_waitcnt lgkmcnt(12)
    v_mfma_f32_32x32x16_bf16 v[16:31], v[136:139], v[168:171], v[16:31]
    v_mfma_f32_32x32x16_bf16 v[64:79], v[136:139], v[172:175], v[64:79]
    s_waitcnt lgkmcnt(9)
    v_mfma_f32_32x32x16_bf16 v[0:15], v[96:99], v[144:147], v[0:15]
    ds_read_b128 v[160:163], v228 offset:0
    ds_read_b64_tr_b16 v[120:121], v224 offset:12352
    s_waitcnt lgkmcnt(10)
    v_mfma_f32_32x32x16_bf16 v[48:63], v[96:99], v[148:151], v[48:63]
    ds_read_b64_tr_b16 v[122:123], v224 offset:13120
    ds_read_b128 v[164:167], v228 offset:4096
    s_waitcnt lgkmcnt(10)
    v_mfma_f32_32x32x16_bf16 v[16:31], v[100:103], v[144:147], v[16:31]
    ds_read_b64_tr_b16 v[124:125], v224 offset:12384
    ds_read_b64_tr_b16 v[126:127], v224 offset:13152
    v_mfma_f32_32x32x16_bf16 v[64:79], v[100:103], v[148:151], v[64:79]
    ds_read_b128 v[168:171], v229 offset:0
    ds_read_b64_tr_b16 v[132:133], v225 offset:12352
    s_waitcnt lgkmcnt(11)
    v_mfma_f32_32x32x16_bf16 v[0:15], v[108:111], v[152:155], v[0:15]
    ds_read_b64_tr_b16 v[134:135], v225 offset:13120
    ds_read_b128 v[172:175], v229 offset:4096
    s_waitcnt lgkmcnt(12)
    v_mfma_f32_32x32x16_bf16 v[48:63], v[108:111], v[156:159], v[48:63]
    ds_read_b64_tr_b16 v[136:137], v225 offset:12384
    ds_read_b64_tr_b16 v[138:139], v225 offset:13152
    s_waitcnt lgkmcnt(12)
    v_mfma_f32_32x32x16_bf16 v[16:31], v[112:115], v[152:155], v[16:31]
    v_mfma_f32_32x32x16_bf16 v[64:79], v[112:115], v[156:159], v[64:79]
    s_waitcnt lgkmcnt(2)
    s_barrier
    v_mfma_f32_32x32x16_bf16 v[0:15], v[120:123], v[160:163], v[0:15]
    ds_read_b128 v[144:147], v226 offset:16384
    ds_read_b64_tr_b16 v[96:97], v224 offset:24704
    v_mfma_f32_32x32x16_bf16 v[48:63], v[120:123], v[164:167], v[48:63]
    ds_read_b64_tr_b16 v[98:99], v224 offset:25472
    ds_read_b128 v[148:151], v226 offset:20480
    v_mfma_f32_32x32x16_bf16 v[16:31], v[124:127], v[160:163], v[16:31]
    ds_read_b64_tr_b16 v[100:101], v224 offset:24736
    ds_read_b64_tr_b16 v[102:103], v224 offset:25504
    v_mfma_f32_32x32x16_bf16 v[64:79], v[124:127], v[164:167], v[64:79]
    ds_read_b128 v[152:155], v227 offset:16384
    ds_read_b64_tr_b16 v[108:109], v225 offset:24704
    v_mfma_f32_32x32x16_bf16 v[0:15], v[132:135], v[168:171], v[0:15]
    ds_read_b64_tr_b16 v[110:111], v225 offset:25472
    ds_read_b128 v[156:159], v227 offset:20480
    v_mfma_f32_32x32x16_bf16 v[48:63], v[132:135], v[172:175], v[48:63]
    ds_read_b64_tr_b16 v[112:113], v225 offset:24736
    ds_read_b64_tr_b16 v[114:115], v225 offset:25504
    s_waitcnt lgkmcnt(12)
    v_mfma_f32_32x32x16_bf16 v[16:31], v[136:139], v[168:171], v[16:31]
    v_mfma_f32_32x32x16_bf16 v[64:79], v[136:139], v[172:175], v[64:79]
    s_waitcnt lgkmcnt(9)
    v_mfma_f32_32x32x16_bf16 v[0:15], v[96:99], v[144:147], v[0:15]
    ds_read_b128 v[160:163], v228 offset:16384
    ds_read_b64_tr_b16 v[120:121], v224 offset:37056
    ds_read_b64_tr_b16 v[122:123], v224 offset:37824
    s_waitcnt lgkmcnt(11)
    v_mfma_f32_32x32x16_bf16 v[48:63], v[96:99], v[148:151], v[48:63]
    ds_read_b128 v[168:171], v229 offset:16384
    ds_read_b64_tr_b16 v[132:133], v225 offset:37056
    ds_read_b64_tr_b16 v[134:135], v225 offset:37824
    s_waitcnt lgkmcnt(12)
    v_mfma_f32_32x32x16_bf16 v[16:31], v[100:103], v[144:147], v[16:31]
    ds_read_b128 v[164:167], v228 offset:20480
    ds_read_b128 v[172:175], v229 offset:20480
    ds_read_b64_tr_b16 v[124:125], v224 offset:37088
    v_mfma_f32_32x32x16_bf16 v[64:79], v[100:103], v[148:151], v[64:79]
    ds_read_b64_tr_b16 v[126:127], v224 offset:37856
    ds_read_b64_tr_b16 v[136:137], v225 offset:37088
    ds_read_b64_tr_b16 v[138:139], v225 offset:37856
    s_waitcnt lgkmcnt(15)
    v_mfma_f32_32x32x16_bf16 v[0:15], v[108:111], v[152:155], v[0:15]
    s_lshl_b32 s30, s4, 2
    s_add_u32 s30, s30, 160928
    v_mov_b32 v176, s30
    v_mov_b32 v177, 1
    ds_write_b32 v176, v177
    v_and_b32 v240, 3, v230
    v_lshlrev_b32 v240, 2, v240
    v_add_u32 v240, 160944, v240
    s_mov_b32 s76, 0
L_sp_29:
    ds_read_b32 v241, v240
    s_waitcnt lgkmcnt(0)
    v_cmp_eq_u32 vcc, 0, v241
    s_cbranch_vccz L_spd_30
    s_sleep 1
    s_add_u32 s76, s76, 1
    s_cmp_lt_u32 s76, 1048576
    s_cbranch_scc1 L_sp_29
L_spd_30:
    ds_read_b64 v[188:189], v234 offset:0
    ds_read_b64 v[192:193], v234 offset:512
    ds_read_b128 v[212:215], v232 offset:0
    ds_read_b128 v[216:219], v232 offset:512
    ds_read_b64 v[236:237], v238
    s_lshl_b32 s30, s4, 2
    s_add_u32 s30, s30, 160992
    v_mov_b32 v178, s30
    v_mov_b32 v179, 1
    ds_write_b32 v178, v179
    v_mfma_f32_32x32x16_bf16 v[48:63], v[108:111], v[156:159], v[48:63]
    v_mfma_f32_32x32x16_bf16 v[16:31], v[112:115], v[152:155], v[16:31]
    v_mfma_f32_32x32x16_bf16 v[64:79], v[112:115], v[156:159], v[64:79]
    s_waitcnt lgkmcnt(1)
    v_mov_b32 v204, v215
    v_mov_b32 v205, v215
    v_mov_b32 v206, v215
    v_mov_b32 v207, v215
    v_mov_b32 v208, v219
    v_mov_b32 v209, v219
    v_mov_b32 v210, v219
    v_mov_b32 v211, v219
    v_readfirstlane_b32 s60, v236
    v_readfirstlane_b32 s61, v237
    v_mfma_f32_32x32x16_bf16 v[0:15], v[120:123], v[160:163], v[0:15]
    v_mfma_f32_32x32x16_bf16 v[0:15], v[132:135], v[168:171], v[0:15]
    v_mfma_f32_32x32x16_bf16 v[0:15], v[188:191], v[204:207], v[0:15]
    s_nop 11
    v_mul_f32 v240, v0, v0
    v_mul_f32 v241, v1, v1
    v_mul_f32 v242, v2, v2
    v_mul_f32 v243, v3, v3
    v_mul_f32 v244, v4, v4
    v_mfma_f32_32x32x16_bf16 v[48:63], v[120:123], v[164:167], v[48:63]
    v_mul_f32 v245, v5, v5
    v_mul_f32 v246, v6, v6
    v_mul_f32 v247, v7, v7
    v_fma_f32 v240, v240, v213, v212
    v_fma_f32 v241, v241, v213, v212
    v_mfma_f32_32x32x16_bf16 v[48:63], v[132:135], v[172:175], v[48:63]
    v_fma_f32 v242, v242, v213, v212
    v_fma_f32 v243, v243, v213, v212
    v_fma_f32 v244, v244, v213, v212
    v_fma_f32 v245, v245, v213, v212
    v_fma_f32 v246, v246, v213, v212
    v_mfma_f32_32x32x16_bf16 v[48:63], v[188:191], v[208:211], v[48:63]
    v_fma_f32 v247, v247, v213, v212
    v_mul_f32 v240, v240, v0
    v_mul_f32 v241, v241, v1
    v_mul_f32 v242, v242, v2
    v_mul_f32 v243, v243, v3
    v_mfma_f32_32x32x16_bf16 v[16:31], v[124:127], v[160:163], v[16:31]
    v_mul_f32 v244, v244, v4
    v_mul_f32 v245, v245, v5
    v_mul_f32 v246, v246, v6
    v_mul_f32 v247, v247, v7
    v_exp_f32 v240, v240
    v_mfma_f32_32x32x16_bf16 v[16:31], v[136:139], v[168:171], v[16:31]
    v_exp_f32 v241, v241
    v_exp_f32 v242, v242
    v_exp_f32 v243, v243
    v_mfma_f32_32x32x16_bf16 v[16:31], v[192:195], v[204:207], v[16:31]
    v_exp_f32 v244, v244
    v_exp_f32 v245, v245
    v_exp_f32 v246, v246
    v_mfma_f32_32x32x16_bf16 v[64:79], v[124:127], v[164:167], v[64:79]
    v_exp_f32 v247, v247
    v_mul_f32 v0, v0, v8
    v_mul_f32 v1, v1, v9
    v_mul_f32 v2, v2, v10
    v_mfma_f32_32x32x16_bf16 v[64:79], v[136:139], v[172:175], v[64:79]
    v_mul_f32 v3, v3, v11
    v_mul_f32 v4, v4, v12
    v_mul_f32 v5, v5, v13
    v_mul_f32 v6, v6, v14
    v_mul_f32 v7, v7, v15
    v_mfma_f32_32x32x16_bf16 v[64:79], v[192:195], v[208:211], v[64:79]
    v_fma_f32 v240, v240, v214, v214
    v_fma_f32 v241, v241, v214, v214
    v_fma_f32 v242, v242, v214, v214
    v_fma_f32 v243, v243, v214, v214
    v_fma_f32 v244, v244, v214, v214
    v_fma_f32 v245, v245, v214, v214
    v_fma_f32 v246, v246, v214, v214
    v_fma_f32 v247, v247, v214, v214
    v_rcp_f32 v240, v240
    v_rcp_f32 v241, v241
    v_rcp_f32 v242, v242
    v_rcp_f32 v243, v243
    v_rcp_f32 v244, v244
    v_rcp_f32 v245, v245
    v_rcp_f32 v246, v246
    v_rcp_f32 v247, v247
    s_nop 0
    v_mul_f32 v0, v0, v240
    v_mul_f32 v1, v1, v241
    v_mul_f32 v2, v2, v242
    v_mul_f32 v3, v3, v243
    v_mul_f32 v4, v4, v244
    v_mul_f32 v5, v5, v245
    v_mul_f32 v6, v6, v246
    v_mul_f32 v7, v7, v247
    v_cvt_pk_bf16_f32 v8, v0, v1
    v_cvt_pk_bf16_f32 v9, v2, v3
    v_cvt_pk_bf16_f32 v10, v4, v5
    v_cvt_pk_bf16_f32 v11, v6, v7
    buffer_store_dwordx4 v[8:11], v231, s[20:23], s34 offen offset:0 sc1
    v_pk_mul_f32 v[240:241], v[48:49], v[48:49]
    v_pk_mul_f32 v[242:243], v[50:51], v[50:51]
    v_pk_mul_f32 v[244:245], v[52:53], v[52:53]
    v_pk_mul_f32 v[246:247], v[54:55], v[54:55]
    v_pk_fma_f32 v[240:241], v[240:241], v[216:217], v[216:217] op_sel:[0,1,0] op_sel_hi:[1,1,0]
    v_pk_fma_f32 v[242:243], v[242:243], v[216:217], v[216:217] op_sel:[0,1,0] op_sel_hi:[1,1,0]
    v_pk_fma_f32 v[244:245], v[244:245], v[216:217], v[216:217] op_sel:[0,1,0] op_sel_hi:[1,1,0]
    v_pk_fma_f32 v[246:247], v[246:247], v[216:217], v[216:217] op_sel:[0,1,0] op_sel_hi:[1,1,0]
    v_pk_mul_f32 v[240:241], v[240:241], v[48:49]
    v_pk_mul_f32 v[242:243], v[242:243], v[50:51]
    v_pk_mul_f32 v[244:245], v[244:245], v[52:53]
    v_pk_mul_f32 v[246:247], v[246:247], v[54:55]
    v_exp_f32 v240, v240
    v_exp_f32 v241, v241
    v_exp_f32 v242, v242
    v_exp_f32 v243, v243
    v_exp_f32 v244, v244
    v_exp_f32 v245, v245
    v_exp_f32 v246, v246
    v_exp_f32 v247, v247
    v_pk_mul_f32 v[48:49], v[48:49], v[56:57]
    v_pk_mul_f32 v[50:51], v[50:51], v[58:59]
    v_pk_mul_f32 v[52:53], v[52:53], v[60:61]
    v_pk_mul_f32 v[54:55], v[54:55], v[62:63]
    v_pk_fma_f32 v[240:241], v[240:241], v[218:219], v[218:219] op_sel_hi:[1,0,0]
    v_pk_fma_f32 v[242:243], v[242:243], v[218:219], v[218:219] op_sel_hi:[1,0,0]
    v_pk_fma_f32 v[244:245], v[244:245], v[218:219], v[218:219] op_sel_hi:[1,0,0]
    v_pk_fma_f32 v[246:247], v[246:247], v[218:219], v[218:219] op_sel_hi:[1,0,0]
    v_rcp_f32 v240, v240
    v_rcp_f32 v241, v241
    v_rcp_f32 v242, v242
    v_rcp_f32 v243, v243
    v_rcp_f32 v244, v244
    v_rcp_f32 v245, v245
    v_rcp_f32 v246, v246
    v_rcp_f32 v247, v247
    s_nop 0
    v_pk_mul_f32 v[48:49], v[48:49], v[240:241]
    v_pk_mul_f32 v[50:51], v[50:51], v[242:243]
    v_pk_mul_f32 v[52:53], v[52:53], v[244:245]
    v_pk_mul_f32 v[54:55], v[54:55], v[246:247]
    v_cvt_pk_bf16_f32 v56, v48, v49
    v_cvt_pk_bf16_f32 v57, v50, v51
    v_cvt_pk_bf16_f32 v58, v52, v53
    v_cvt_pk_bf16_f32 v59, v54, v55
    buffer_store_dwordx4 v[56:59], v231, s[20:23], s33 offen offset:0 sc1
    v_pk_mul_f32 v[240:241], v[16:17], v[16:17]
    v_pk_mul_f32 v[242:243], v[18:19], v[18:19]
    v_pk_mul_f32 v[244:245], v[20:21], v[20:21]
    v_pk_mul_f32 v[246:247], v[22:23], v[22:23]
    v_pk_fma_f32 v[240:241], v[240:241], v[212:213], v[212:213] op_sel:[0,1,0] op_sel_hi:[1,1,0]
    v_pk_fma_f32 v[242:243], v[242:243], v[212:213], v[212:213] op_sel:[0,1,0] op_sel_hi:[1,1,0]
    v_pk_fma_f32 v[244:245], v[244:245], v[212:213], v[212:213] op_sel:[0,1,0] op_sel_hi:[1,1,0]
    v_pk_fma_f32 v[246:247], v[246:247], v[212:213], v[212:213] op_sel:[0,1,0] op_sel_hi:[1,1,0]
    v_pk_mul_f32 v[240:241], v[240:241], v[16:17]
    v_pk_mul_f32 v[242:243], v[242:243], v[18:19]
    v_pk_mul_f32 v[244:245], v[244:245], v[20:21]
    v_pk_mul_f32 v[246:247], v[246:247], v[22:23]
    v_exp_f32 v240, v240
    v_exp_f32 v241, v241
    v_exp_f32 v242, v242
    v_exp_f32 v243, v243
    v_exp_f32 v244, v244
    v_exp_f32 v245, v245
    v_exp_f32 v246, v246
    v_exp_f32 v247, v247
    v_pk_mul_f32 v[16:17], v[16:17], v[24:25]
    v_pk_mul_f32 v[18:19], v[18:19], v[26:27]
    v_pk_mul_f32 v[20:21], v[20:21], v[28:29]
    v_pk_mul_f32 v[22:23], v[22:23], v[30:31]
    v_pk_fma_f32 v[240:241], v[240:241], v[214:215], v[214:215] op_sel_hi:[1,0,0]
    v_pk_fma_f32 v[242:243], v[242:243], v[214:215], v[214:215] op_sel_hi:[1,0,0]
    v_pk_fma_f32 v[244:245], v[244:245], v[214:215], v[214:215] op_sel_hi:[1,0,0]
    v_pk_fma_f32 v[246:247], v[246:247], v[214:215], v[214:215] op_sel_hi:[1,0,0]
    v_rcp_f32 v240, v240
    v_rcp_f32 v241, v241
    v_rcp_f32 v242, v242
    v_rcp_f32 v243, v243
    v_rcp_f32 v244, v244
    v_rcp_f32 v245, v245
    v_rcp_f32 v246, v246
    v_rcp_f32 v247, v247
    s_nop 0
    v_pk_mul_f32 v[16:17], v[16:17], v[240:241]
    v_pk_mul_f32 v[18:19], v[18:19], v[242:243]
    v_pk_mul_f32 v[20:21], v[20:21], v[244:245]
    v_pk_mul_f32 v[22:23], v[22:23], v[246:247]
    v_cvt_pk_bf16_f32 v24, v16, v17
    v_cvt_pk_bf16_f32 v25, v18, v19
    v_cvt_pk_bf16_f32 v26, v20, v21
    v_cvt_pk_bf16_f32 v27, v22, v23
    buffer_store_dwordx4 v[24:27], v231, s[20:23], s34 offen offset:1024 sc1
    s_lshl_b32 s30, s4, 2
    s_add_u32 s30, s30, 160896
    v_mov_b32 v176, s30
    v_mov_b32 v177, 1
    ds_write_b32 v176, v177
    v_pk_mul_f32 v[240:241], v[64:65], v[64:65]
    v_pk_mul_f32 v[242:243], v[66:67], v[66:67]
    v_pk_mul_f32 v[244:245], v[68:69], v[68:69]
    v_pk_mul_f32 v[246:247], v[70:71], v[70:71]
    v_pk_fma_f32 v[240:241], v[240:241], v[216:217], v[216:217] op_sel:[0,1,0] op_sel_hi:[1,1,0]
    v_pk_fma_f32 v[242:243], v[242:243], v[216:217], v[216:217] op_sel:[0,1,0] op_sel_hi:[1,1,0]
    v_pk_fma_f32 v[244:245], v[244:245], v[216:217], v[216:217] op_sel:[0,1,0] op_sel_hi:[1,1,0]
    v_pk_fma_f32 v[246:247], v[246:247], v[216:217], v[216:217] op_sel:[0,1,0] op_sel_hi:[1,1,0]
    v_pk_mul_f32 v[240:241], v[240:241], v[64:65]
    v_pk_mul_f32 v[242:243], v[242:243], v[66:67]
    v_pk_mul_f32 v[244:245], v[244:245], v[68:69]
    v_pk_mul_f32 v[246:247], v[246:247], v[70:71]
    v_exp_f32 v240, v240
    v_exp_f32 v241, v241
    v_exp_f32 v242, v242
    v_exp_f32 v243, v243
    v_exp_f32 v244, v244
    v_exp_f32 v245, v245
    v_exp_f32 v246, v246
    v_exp_f32 v247, v247
    v_pk_mul_f32 v[64:65], v[64:65], v[72:73]
    v_pk_mul_f32 v[66:67], v[66:67], v[74:75]
    v_pk_mul_f32 v[68:69], v[68:69], v[76:77]
    v_pk_mul_f32 v[70:71], v[70:71], v[78:79]
    v_pk_fma_f32 v[240:241], v[240:241], v[218:219], v[218:219] op_sel_hi:[1,0,0]
    v_pk_fma_f32 v[242:243], v[242:243], v[218:219], v[218:219] op_sel_hi:[1,0,0]
    v_pk_fma_f32 v[244:245], v[244:245], v[218:219], v[218:219] op_sel_hi:[1,0,0]
    v_pk_fma_f32 v[246:247], v[246:247], v[218:219], v[218:219] op_sel_hi:[1,0,0]
    v_rcp_f32 v240, v240
    v_rcp_f32 v241, v241
    v_rcp_f32 v242, v242
    v_rcp_f32 v243, v243
    v_rcp_f32 v244, v244
    v_rcp_f32 v245, v245
    v_rcp_f32 v246, v246
    v_rcp_f32 v247, v247
    s_nop 0
    v_pk_mul_f32 v[64:65], v[64:65], v[240:241]
    v_pk_mul_f32 v[66:67], v[66:67], v[242:243]
    v_pk_mul_f32 v[68:69], v[68:69], v[244:245]
    v_pk_mul_f32 v[70:71], v[70:71], v[246:247]
    v_cvt_pk_bf16_f32 v72, v64, v65
    v_cvt_pk_bf16_f32 v73, v66, v67
    v_cvt_pk_bf16_f32 v74, v68, v69
    v_cvt_pk_bf16_f32 v75, v70, v71
    buffer_store_dwordx4 v[72:75], v231, s[20:23], s33 offen offset:1024 sc1
    v_mov_b32 v240, 160776
    v_mov_b32 v241, 1
    s_waitcnt vmcnt(0)
    s_mov_b64 exec, 1
    ds_add_rtn_u32 v242, v240, v241
    s_mov_b64 exec, -1
    s_waitcnt lgkmcnt(0)
    v_readfirstlane_b32 s55, v242
    s_cmp_lg_u32 s55, 3
    s_cbranch_scc1 L_n0_31
    v_lshl_add_u32 v241, v230, 3, s35
    v_mov_b32 v242, s60
    v_mov_b32 v243, s61
    s_mov_b64 exec, 0xffff
    global_store_dwordx2 v241, v[242:243], s[10:11] sc1
    s_mov_b64 exec, -1
L_n0_31:
    s_branch K_B
K_c3:
    s_lshl_b32 s30, s2, 2
    s_add_u32 s30, s30, s4
    s_mul_i32 s30, s30, 1408
    v_lshlrev_b32 v246, 7, v230
    s_mov_b64 exec, 0x7ff
    buffer_load_dword v247, v246, s[64:67], s30 offen
    s_mov_b64 exec, -1
    s_setprio 3
    s_barrier
    ds_read_b128 v[144:147], v226 offset:0
    ds_read_b64_tr_b16 v[96:97], v222 offset:0
    ds_read_b64_tr_b16 v[98:99], v222 offset:768
    ds_read_b128 v[148:151], v226 offset:4096
    ds_read_b64_tr_b16 v[100:101], v222 offset:32
    ds_read_b64_tr_b16 v[102:103], v222 offset:800
    ds_read_b64_tr_b16 v[104:105], v222 offset:64
    ds_read_b64_tr_b16 v[106:107], v222 offset:832
    ds_read_b128 v[152:155], v227 offset:0
    ds_read_b64_tr_b16 v[108:109], v223 offset:0
    ds_read_b64_tr_b16 v[110:111], v223 offset:768
    ds_read_b128 v[156:159], v227 offset:4096
    ds_read_b64_tr_b16 v[112:113], v223 offset:32
    ds_read_b64_tr_b16 v[114:115], v223 offset:800
    ds_read_b64_tr_b16 v[116:117], v223 offset:64
    ds_read_b64_tr_b16 v[118:119], v223 offset:832
    s_waitcnt lgkmcnt(4)
    s_barrier
    v_mfma_f32_32x32x16_bf16 v[0:15], v[96:99], v[144:147], 0
    ds_read_b128 v[160:163], v228 offset:0
    ds_read_b64_tr_b16 v[120:121], v222 offset:12352
    v_mfma_f32_32x32x16_bf16 v[48:63], v[96:99], v[148:151], 0
    ds_read_b64_tr_b16 v[122:123], v222 offset:13120
    ds_read_b128 v[164:167], v228 offset:4096
    v_mfma_f32_16x16x32_bf16 v[176:179], v[200:203], v[96:99], 0
    v_mfma_f32_32x32x16_bf16 v[16:31], v[100:103], v[144:147], 0
    ds_read_b64_tr_b16 v[124:125], v222 offset:12384
    v_mfma_f32_32x32x16_bf16 v[64:79], v[100:103], v[148:151], 0
    ds_read_b64_tr_b16 v[126:127], v222 offset:13152
    ds_read_b64_tr_b16 v[128:129], v222 offset:12416
    v_mfma_f32_16x16x32_bf16 v[180:183], v[200:203], v[100:103], 0
    v_mfma_f32_32x32x16_bf16 v[32:47], v[104:107], v[144:147], 0
    ds_read_b64_tr_b16 v[130:131], v222 offset:13184
    v_mfma_f32_32x32x16_bf16 v[80:95], v[104:107], v[148:151], 0
    ds_read_b128 v[168:171], v229 offset:0
    ds_read_b64_tr_b16 v[132:133], v223 offset:12352
    v_mfma_f32_16x16x32_bf16 v[184:187], v[200:203], v[104:107], 0
    v_mfma_f32_32x32x16_bf16 v[0:15], v[108:111], v[152:155], v[0:15]
    ds_read_b64_tr_b16 v[134:135], v223 offset:13120
    ds_read_b128 v[172:175], v229 offset:4096
    v_mfma_f32_32x32x16_bf16 v[48:63], v[108:111], v[156:159], v[48:63]
    ds_read_b64_tr_b16 v[136:137], v223 offset:12384
    s_waitcnt lgkmcnt(15)
    v_mfma_f32_32x32x16_bf16 v[16:31], v[112:115], v[152:155], v[16:31]
    ds_read_b64_tr_b16 v[138:139], v223 offset:13152
    ds_read_b64_tr_b16 v[140:141], v223 offset:12416
    v_mfma_f32_32x32x16_bf16 v[64:79], v[112:115], v[156:159], v[64:79]
    ds_read_b64_tr_b16 v[142:143], v223 offset:13184
    s_waitcnt lgkmcnt(15)
    v_mfma_f32_32x32x16_bf16 v[32:47], v[116:119], v[152:155], v[32:47]
    v_mfma_f32_32x32x16_bf16 v[80:95], v[116:119], v[156:159], v[80:95]
    s_nop 3
    s_mov_b32 exec_hi, 0
    ds_write_b32 v233, v176 offset:0
    ds_write_b32 v233, v180 offset:4
    ds_write_b32 v233, v184 offset:8
    s_mov_b32 exec_hi, -1
    s_waitcnt lgkmcnt(0)
    s_barrier
    v_mfma_f32_32x32x16_bf16 v[0:15], v[120:123], v[160:163], v[0:15]
    ds_read_b128 v[144:147], v226 offset:16384
    ds_read_b64_tr_b16 v[96:97], v222 offset:24704
    v_mfma_f32_32x32x16_bf16 v[48:63], v[120:123], v[164:167], v[48:63]
    ds_read_b64_tr_b16 v[98:99], v222 offset:25472
    ds_read_b128 v[148:151], v226 offset:20480
    v_mfma_f32_32x32x16_bf16 v[16:31], v[124:127], v[160:163], v[16:31]
    ds_read_b64_tr_b16 v[100:101], v222 offset:24736
    v_mfma_f32_32x32x16_bf16 v[64:79], v[124:127], v[164:167], v[64:79]
    ds_read_b64_tr_b16 v[102:103], v222 offset:25504
    ds_read_b64_tr_b16 v[104:105], v222 offset:24768
    v_mfma_f32_32x32x16_bf16 v[32:47], v[128:131], v[160:163], v[32:47]
    ds_read_b64_tr_b16 v[106:107], v222 offset:25536
    v_mfma_f32_32x32x16_bf16 v[80:95], v[128:131], v[164:167], v[80:95]
    ds_read_b128 v[152:155], v227 offset:16384
    ds_read_b64_tr_b16 v[108:109], v223 offset:24704
    v_mfma_f32_32x32x16_bf16 v[0:15], v[132:135], v[168:171], v[0:15]
    ds_read_b64_tr_b16 v[110:111], v223 offset:25472
    ds_read_b128 v[156:159], v227 offset:20480
    v_mfma_f32_32x32x16_bf16 v[48:63], v[132:135], v[172:175], v[48:63]
    ds_read_b64_tr_b16 v[112:113], v223 offset:24736
    v_mfma_f32_32x32x16_bf16 v[16:31], v[136:139], v[168:171], v[16:31]
    ds_read_b64_tr_b16 v[114:115], v223 offset:25504
    ds_read_b64_tr_b16 v[116:117], v223 offset:24768
    v_mfma_f32_32x32x16_bf16 v[64:79], v[136:139], v[172:175], v[64:79]
    ds_read_b64_tr_b16 v[118:119], v223 offset:25536
    v_mfma_f32_32x32x16_bf16 v[32:47], v[140:143], v[168:171], v[32:47]
    v_mfma_f32_32x32x16_bf16 v[80:95], v[140:143], v[172:175], v[80:95]
    s_waitcnt lgkmcnt(13)
    v_mfma_f32_32x32x16_bf16 v[0:15], v[96:99], v[144:147], v[0:15]
    ds_read_b128 v[160:163], v228 offset:16384
    ds_read_b64_tr_b16 v[120:121], v222 offset:37056
    s_waitcnt lgkmcnt(14)
    v_mfma_f32_32x32x16_bf16 v[48:63], v[96:99], v[148:151], v[48:63]
    ds_read_b64_tr_b16 v[122:123], v222 offset:37824
    ds_read_b128 v[164:167], v228 offset:20480
    s_waitcnt lgkmcnt(14)
    v_mfma_f32_32x32x16_bf16 v[16:31], v[100:103], v[144:147], v[16:31]
    ds_read_b64_tr_b16 v[124:125], v222 offset:37088
    v_mfma_f32_32x32x16_bf16 v[64:79], v[100:103], v[148:151], v[64:79]
    ds_read_b64_tr_b16 v[126:127], v222 offset:37856
    ds_read_b64_tr_b16 v[128:129], v222 offset:37120
    s_waitcnt lgkmcnt(15)
    v_mfma_f32_32x32x16_bf16 v[32:47], v[104:107], v[144:147], v[32:47]
    ds_read_b64_tr_b16 v[130:131], v222 offset:37888
    v_mfma_f32_32x32x16_bf16 v[80:95], v[104:107], v[148:151], v[80:95]
    ds_read_b128 v[168:171], v229 offset:16384
    ds_read_b64_tr_b16 v[132:133], v223 offset:37056
    s_waitcnt lgkmcnt(15)
    v_mfma_f32_32x32x16_bf16 v[0:15], v[108:111], v[152:155], v[0:15]
    ds_read_b64_tr_b16 v[134:135], v223 offset:37824
    ds_read_b128 v[172:175], v229 offset:20480
    s_waitcnt lgkmcnt(15)
    v_mfma_f32_32x32x16_bf16 v[48:63], v[108:111], v[156:159], v[48:63]
    ds_read_b64_tr_b16 v[136:137], v223 offset:37088
    s_waitcnt lgkmcnt(15)
    v_mfma_f32_32x32x16_bf16 v[16:31], v[112:115], v[152:155], v[16:31]
    ds_read_b64_tr_b16 v[138:139], v223 offset:37856
    ds_read_b64_tr_b16 v[140:141], v223 offset:37120
    v_mfma_f32_32x32x16_bf16 v[64:79], v[112:115], v[156:159], v[64:79]
    ds_read_b64_tr_b16 v[142:143], v223 offset:37888
    s_waitcnt lgkmcnt(15)
    v_mfma_f32_32x32x16_bf16 v[32:47], v[116:119], v[152:155], v[32:47]
    v_mfma_f32_32x32x16_bf16 v[80:95], v[116:119], v[156:159], v[80:95]
    s_waitcnt lgkmcnt(4)
    s_barrier
    v_mfma_f32_32x32x16_bf16 v[0:15], v[120:123], v[160:163], v[0:15]
    ds_read_b128 v[144:147], v226 offset:32768
    ds_read_b64_tr_b16 v[96:97], v224 offset:0
    v_mfma_f32_32x32x16_bf16 v[48:63], v[120:123], v[164:167], v[48:63]
    ds_read_b64_tr_b16 v[98:99], v224 offset:768
    ds_read_b128 v[148:151], v226 offset:36864
    v_mfma_f32_32x32x16_bf16 v[16:31], v[124:127], v[160:163], v[16:31]
    ds_read_b64_tr_b16 v[100:101], v224 offset:32
    v_mfma_f32_32x32x16_bf16 v[64:79], v[124:127], v[164:167], v[64:79]
    ds_read_b64_tr_b16 v[102:103], v224 offset:800
    ds_read_b64_tr_b16 v[104:105], v224 offset:64
    v_mfma_f32_32x32x16_bf16 v[32:47], v[128:131], v[160:163], v[32:47]
    ds_read_b64_tr_b16 v[106:107], v224 offset:832
    v_mfma_f32_32x32x16_bf16 v[80:95], v[128:131], v[164:167], v[80:95]
    ds_read_b128 v[152:155], v227 offset:32768
    ds_read_b64_tr_b16 v[108:109], v225 offset:0
    v_mfma_f32_32x32x16_bf16 v[0:15], v[132:135], v[168:171], v[0:15]
    ds_read_b64_tr_b16 v[110:111], v225 offset:768
    ds_read_b128 v[156:159], v227 offset:36864
    v_mfma_f32_32x32x16_bf16 v[48:63], v[132:135], v[172:175], v[48:63]
    ds_read_b64_tr_b16 v[112:113], v225 offset:32
    s_waitcnt lgkmcnt(15)
    v_mfma_f32_32x32x16_bf16 v[16:31], v[136:139], v[168:171], v[16:31]
    ds_read_b64_tr_b16 v[114:115], v225 offset:800
    ds_read_b64_tr_b16 v[116:117], v225 offset:64
    v_mfma_f32_32x32x16_bf16 v[64:79], v[136:139], v[172:175], v[64:79]
    ds_read_b64_tr_b16 v[118:119], v225 offset:832
    s_waitcnt lgkmcnt(15)
    v_mfma_f32_32x32x16_bf16 v[32:47], v[140:143], v[168:171], v[32:47]
    v_mfma_f32_32x32x16_bf16 v[80:95], v[140:143], v[172:175], v[80:95]
    s_waitcnt lgkmcnt(13)
    v_mfma_f32_32x32x16_bf16 v[0:15], v[96:99], v[144:147], v[0:15]
    ds_read_b128 v[160:163], v228 offset:32768
    ds_read_b64_tr_b16 v[120:121], v224 offset:12352
    s_waitcnt lgkmcnt(14)
    v_mfma_f32_32x32x16_bf16 v[48:63], v[96:99], v[148:151], v[48:63]
    ds_read_b64_tr_b16 v[122:123], v224 offset:13120
    ds_read_b128 v[164:167], v228 offset:36864
    s_waitcnt lgkmcnt(14)
    v_mfma_f32_32x32x16_bf16 v[16:31], v[100:103], v[144:147], v[16:31]
    ds_read_b64_tr_b16 v[124:125], v224 offset:12384
    v_mfma_f32_32x32x16_bf16 v[64:79], v[100:103], v[148:151], v[64:79]
    ds_read_b64_tr_b16 v[126:127], v224 offset:13152
    ds_read_b64_tr_b16 v[128:129], v224 offset:12416
    s_waitcnt lgkmcnt(15)
    v_mfma_f32_32x32x16_bf16 v[32:47], v[104:107], v[144:147], v[32:47]
    ds_read_b64_tr_b16 v[130:131], v224 offset:13184
    v_mfma_f32_32x32x16_bf16 v[80:95], v[104:107], v[148:151], v[80:95]
    ds_read_b128 v[168:171], v229 offset:32768
    ds_read_b64_tr_b16 v[132:133], v225 offset:12352
    s_waitcnt lgkmcnt(15)
    v_mfma_f32_32x32x16_bf16 v[0:15], v[108:111], v[152:155], v[0:15]
    ds_read_b64_tr_b16 v[134:135], v225 offset:13120
    ds_read_b128 v[172:175], v229 offset:36864
    s_waitcnt lgkmcnt(15)
    v_mfma_f32_32x32x16_bf16 v[48:63], v[108:111], v[156:159], v[48:63]
    ds_read_b64_tr_b16 v[136:137], v225 offset:12384
    s_waitcnt lgkmcnt(15)
    v_mfma_f32_32x32x16_bf16 v[16:31], v[112:115], v[152:155], v[16:31]
    ds_read_b64_tr_b16 v[138:139], v225 offset:13152
    ds_read_b64_tr_b16 v[140:141], v225 offset:12416
    v_mfma_f32_32x32x16_bf16 v[64:79], v[112:115], v[156:159], v[64:79]
    ds_read_b64_tr_b16 v[142:143], v225 offset:13184
    s_waitcnt lgkmcnt(15)
    v_mfma_f32_32x32x16_bf16 v[32:47], v[116:119], v[152:155], v[32:47]
    v_mfma_f32_32x32x16_bf16 v[80:95], v[116:119], v[156:159], v[80:95]
    s_waitcnt lgkmcnt(4)
    s_barrier
    v_mfma_f32_32x32x16_bf16 v[0:15], v[120:123], v[160:163], v[0:15]
    ds_read_b128 v[144:147], v226 offset:0
    ds_read_b64_tr_b16 v[96:97], v224 offset:24704
    v_mfma_f32_32x32x16_bf16 v[48:63], v[120:123], v[164:167], v[48:63]
    ds_read_b64_tr_b16 v[98:99], v224 offset:25472
    ds_read_b128 v[148:151], v226 offset:4096
    v_mfma_f32_32x32x16_bf16 v[16:31], v[124:127], v[160:163], v[16:31]
    ds_read_b64_tr_b16 v[100:101], v224 offset:24736
    v_mfma_f32_32x32x16_bf16 v[64:79], v[124:127], v[164:167], v[64:79]
    ds_read_b64_tr_b16 v[102:103], v224 offset:25504
    ds_read_b64_tr_b16 v[104:105], v224 offset:24768
    v_mfma_f32_32x32x16_bf16 v[32:47], v[128:131], v[160:163], v[32:47]
    ds_read_b64_tr_b16 v[106:107], v224 offset:25536
    v_mfma_f32_32x32x16_bf16 v[80:95], v[128:131], v[164:167], v[80:95]
    ds_read_b128 v[152:155], v227 offset:0
    ds_read_b64_tr_b16 v[108:109], v225 offset:24704
    v_mfma_f32_32x32x16_bf16 v[0:15], v[132:135], v[168:171], v[0:15]
    ds_read_b64_tr_b16 v[110:111], v225 offset:25472
    ds_read_b128 v[156:159], v227 offset:4096
    v_mfma_f32_32x32x16_bf16 v[48:63], v[132:135], v[172:175], v[48:63]
    ds_read_b64_tr_b16 v[112:113], v225 offset:24736
    s_waitcnt lgkmcnt(15)
    v_mfma_f32_32x32x16_bf16 v[16:31], v[136:139], v[168:171], v[16:31]
    ds_read_b64_tr_b16 v[114:115], v225 offset:25504
    ds_read_b64_tr_b16 v[116:117], v225 offset:24768
    v_mfma_f32_32x32x16_bf16 v[64:79], v[136:139], v[172:175], v[64:79]
    ds_read_b64_tr_b16 v[118:119], v225 offset:25536
    s_waitcnt lgkmcnt(15)
    v_mfma_f32_32x32x16_bf16 v[32:47], v[140:143], v[168:171], v[32:47]
    v_mfma_f32_32x32x16_bf16 v[80:95], v[140:143], v[172:175], v[80:95]
    s_waitcnt lgkmcnt(13)
    v_mfma_f32_32x32x16_bf16 v[0:15], v[96:99], v[144:147], v[0:15]
    ds_read_b128 v[160:163], v228 offset:0
    ds_read_b64_tr_b16 v[120:121], v224 offset:37056
    s_waitcnt lgkmcnt(14)
    v_mfma_f32_32x32x16_bf16 v[48:63], v[96:99], v[148:151], v[48:63]
    ds_read_b64_tr_b16 v[122:123], v224 offset:37824
    ds_read_b128 v[164:167], v228 offset:4096
    s_waitcnt lgkmcnt(14)
    v_mfma_f32_32x32x16_bf16 v[16:31], v[100:103], v[144:147], v[16:31]
    ds_read_b64_tr_b16 v[124:125], v224 offset:37088
    v_mfma_f32_32x32x16_bf16 v[64:79], v[100:103], v[148:151], v[64:79]
    ds_read_b64_tr_b16 v[126:127], v224 offset:37856
    ds_read_b64_tr_b16 v[128:129], v224 offset:37120
    s_waitcnt lgkmcnt(15)
    v_mfma_f32_32x32x16_bf16 v[32:47], v[104:107], v[144:147], v[32:47]
    ds_read_b64_tr_b16 v[130:131], v224 offset:37888
    v_mfma_f32_32x32x16_bf16 v[80:95], v[104:107], v[148:151], v[80:95]
    ds_read_b128 v[168:171], v229 offset:0
    ds_read_b64_tr_b16 v[132:133], v225 offset:37056
    s_waitcnt lgkmcnt(15)
    v_mfma_f32_32x32x16_bf16 v[0:15], v[108:111], v[152:155], v[0:15]
    ds_read_b64_tr_b16 v[134:135], v225 offset:37824
    ds_read_b128 v[172:175], v229 offset:4096
    s_waitcnt lgkmcnt(15)
    v_mfma_f32_32x32x16_bf16 v[48:63], v[108:111], v[156:159], v[48:63]
    ds_read_b64_tr_b16 v[136:137], v225 offset:37088
    s_waitcnt lgkmcnt(15)
    v_mfma_f32_32x32x16_bf16 v[16:31], v[112:115], v[152:155], v[16:31]
    ds_read_b64_tr_b16 v[138:139], v225 offset:37856
    ds_read_b64_tr_b16 v[140:141], v225 offset:37120
    v_mfma_f32_32x32x16_bf16 v[64:79], v[112:115], v[156:159], v[64:79]
    ds_read_b64_tr_b16 v[142:143], v225 offset:37888
    s_waitcnt lgkmcnt(15)
    v_mfma_f32_32x32x16_bf16 v[32:47], v[116:119], v[152:155], v[32:47]
    v_mfma_f32_32x32x16_bf16 v[80:95], v[116:119], v[156:159], v[80:95]
    s_waitcnt lgkmcnt(4)
    s_barrier
    v_mfma_f32_32x32x16_bf16 v[0:15], v[120:123], v[160:163], v[0:15]
    ds_read_b128 v[144:147], v226 offset:16384
    ds_read_b64_tr_b16 v[96:97], v222 offset:0
    v_mfma_f32_32x32x16_bf16 v[48:63], v[120:123], v[164:167], v[48:63]
    ds_read_b64_tr_b16 v[98:99], v222 offset:768
    ds_read_b128 v[148:151], v226 offset:20480
    v_mfma_f32_32x32x16_bf16 v[16:31], v[124:127], v[160:163], v[16:31]
    ds_read_b64_tr_b16 v[100:101], v222 offset:32
    v_mfma_f32_32x32x16_bf16 v[64:79], v[124:127], v[164:167], v[64:79]
    ds_read_b64_tr_b16 v[102:103], v222 offset:800
    ds_read_b64_tr_b16 v[104:105], v222 offset:64
    v_mfma_f32_32x32x16_bf16 v[32:47], v[128:131], v[160:163], v[32:47]
    ds_read_b64_tr_b16 v[106:107], v222 offset:832
    v_mfma_f32_32x32x16_bf16 v[80:95], v[128:131], v[164:167], v[80:95]
    ds_read_b128 v[152:155], v227 offset:16384
    ds_read_b64_tr_b16 v[108:109], v223 offset:0
    v_mfma_f32_32x32x16_bf16 v[0:15], v[132:135], v[168:171], v[0:15]
    ds_read_b64_tr_b16 v[110:111], v223 offset:768
    ds_read_b128 v[156:159], v227 offset:20480
    v_mfma_f32_32x32x16_bf16 v[48:63], v[132:135], v[172:175], v[48:63]
    ds_read_b64_tr_b16 v[112:113], v223 offset:32
    s_waitcnt lgkmcnt(15)
    v_mfma_f32_32x32x16_bf16 v[16:31], v[136:139], v[168:171], v[16:31]
    ds_read_b64_tr_b16 v[114:115], v223 offset:800
    ds_read_b64_tr_b16 v[116:117], v223 offset:64
    v_mfma_f32_32x32x16_bf16 v[64:79], v[136:139], v[172:175], v[64:79]
    ds_read_b64_tr_b16 v[118:119], v223 offset:832
    s_waitcnt lgkmcnt(15)
    v_mfma_f32_32x32x16_bf16 v[32:47], v[140:143], v[168:171], v[32:47]
    v_mfma_f32_32x32x16_bf16 v[80:95], v[140:143], v[172:175], v[80:95]
    s_waitcnt lgkmcnt(13)
    v_mfma_f32_32x32x16_bf16 v[0:15], v[96:99], v[144:147], v[0:15]
    ds_read_b128 v[160:163], v228 offset:16384
    ds_read_b64_tr_b16 v[120:121], v222 offset:12352
    s_waitcnt lgkmcnt(14)
    v_mfma_f32_32x32x16_bf16 v[48:63], v[96:99], v[148:151], v[48:63]
    ds_read_b64_tr_b16 v[122:123], v222 offset:13120
    ds_read_b128 v[164:167], v228 offset:20480
    s_waitcnt lgkmcnt(14)
    v_mfma_f32_32x32x16_bf16 v[16:31], v[100:103], v[144:147], v[16:31]
    ds_read_b64_tr_b16 v[124:125], v222 offset:12384
    v_mfma_f32_32x32x16_bf16 v[64:79], v[100:103], v[148:151], v[64:79]
    ds_read_b64_tr_b16 v[126:127], v222 offset:13152
    ds_read_b64_tr_b16 v[128:129], v222 offset:12416
    s_waitcnt lgkmcnt(15)
    v_mfma_f32_32x32x16_bf16 v[32:47], v[104:107], v[144:147], v[32:47]
    ds_read_b64_tr_b16 v[130:131], v222 offset:13184
    v_mfma_f32_32x32x16_bf16 v[80:95], v[104:107], v[148:151], v[80:95]
    ds_read_b128 v[168:171], v229 offset:16384
    ds_read_b64_tr_b16 v[132:133], v223 offset:12352
    s_waitcnt lgkmcnt(15)
    v_mfma_f32_32x32x16_bf16 v[0:15], v[108:111], v[152:155], v[0:15]
    ds_read_b64_tr_b16 v[134:135], v223 offset:13120
    ds_read_b128 v[172:175], v229 offset:20480
    s_waitcnt lgkmcnt(15)
    v_mfma_f32_32x32x16_bf16 v[48:63], v[108:111], v[156:159], v[48:63]
    ds_read_b64_tr_b16 v[136:137], v223 offset:12384
    s_waitcnt lgkmcnt(15)
    v_mfma_f32_32x32x16_bf16 v[16:31], v[112:115], v[152:155], v[16:31]
    ds_read_b64_tr_b16 v[138:139], v223 offset:13152
    ds_read_b64_tr_b16 v[140:141], v223 offset:12416
    v_mfma_f32_32x32x16_bf16 v[64:79], v[112:115], v[156:159], v[64:79]
    ds_read_b64_tr_b16 v[142:143], v223 offset:13184
    s_waitcnt lgkmcnt(15)
    v_mfma_f32_32x32x16_bf16 v[32:47], v[116:119], v[152:155], v[32:47]
    v_mfma_f32_32x32x16_bf16 v[80:95], v[116:119], v[156:159], v[80:95]
    s_waitcnt lgkmcnt(4)
    s_barrier
    v_mfma_f32_32x32x16_bf16 v[0:15], v[120:123], v[160:163], v[0:15]
    ds_read_b128 v[144:147], v226 offset:32768
    ds_read_b64_tr_b16 v[96:97], v222 offset:24704
    v_mfma_f32_32x32x16_bf16 v[48:63], v[120:123], v[164:167], v[48:63]
    ds_read_b64_tr_b16 v[98:99], v222 offset:25472
    ds_read_b128 v[148:151], v226 offset:36864
    v_mfma_f32_32x32x16_bf16 v[16:31], v[124:127], v[160:163], v[16:31]
    ds_read_b64_tr_b16 v[100:101], v222 offset:24736
    v_mfma_f32_32x32x16_bf16 v[64:79], v[124:127], v[164:167], v[64:79]
    ds_read_b64_tr_b16 v[102:103], v222 offset:25504
    ds_read_b64_tr_b16 v[104:105], v222 offset:24768
    v_mfma_f32_32x32x16_bf16 v[32:47], v[128:131], v[160:163], v[32:47]
    ds_read_b64_tr_b16 v[106:107], v222 offset:25536
    v_mfma_f32_32x32x16_bf16 v[80:95], v[128:131], v[164:167], v[80:95]
    ds_read_b128 v[152:155], v227 offset:32768
    ds_read_b64_tr_b16 v[108:109], v223 offset:24704
    v_mfma_f32_32x32x16_bf16 v[0:15], v[132:135], v[168:171], v[0:15]
    ds_read_b64_tr_b16 v[110:111], v223 offset:25472
    ds_read_b128 v[156:159], v227 offset:36864
    v_mfma_f32_32x32x16_bf16 v[48:63], v[132:135], v[172:175], v[48:63]
    ds_read_b64_tr_b16 v[112:113], v223 offset:24736
    s_waitcnt lgkmcnt(15)
    v_mfma_f32_32x32x16_bf16 v[16:31], v[136:139], v[168:171], v[16:31]
    ds_read_b64_tr_b16 v[114:115], v223 offset:25504
    ds_read_b64_tr_b16 v[116:117], v223 offset:24768
    v_mfma_f32_32x32x16_bf16 v[64:79], v[136:139], v[172:175], v[64:79]
    ds_read_b64_tr_b16 v[118:119], v223 offset:25536
    s_waitcnt lgkmcnt(15)
    v_mfma_f32_32x32x16_bf16 v[32:47], v[140:143], v[168:171], v[32:47]
    v_mfma_f32_32x32x16_bf16 v[80:95], v[140:143], v[172:175], v[80:95]
    s_waitcnt lgkmcnt(13)
    v_mfma_f32_32x32x16_bf16 v[0:15], v[96:99], v[144:147], v[0:15]
    ds_read_b128 v[160:163], v228 offset:32768
    ds_read_b64_tr_b16 v[120:121], v222 offset:37056
    s_waitcnt lgkmcnt(14)
    v_mfma_f32_32x32x16_bf16 v[48:63], v[96:99], v[148:151], v[48:63]
    ds_read_b64_tr_b16 v[122:123], v222 offset:37824
    ds_read_b128 v[164:167], v228 offset:36864
    s_waitcnt lgkmcnt(14)
    v_mfma_f32_32x32x16_bf16 v[16:31], v[100:103], v[144:147], v[16:31]
    ds_read_b64_tr_b16 v[124:125], v222 offset:37088
    v_mfma_f32_32x32x16_bf16 v[64:79], v[100:103], v[148:151], v[64:79]
    ds_read_b64_tr_b16 v[126:127], v222 offset:37856
    ds_read_b64_tr_b16 v[128:129], v222 offset:37120
    s_waitcnt lgkmcnt(15)
    v_mfma_f32_32x32x16_bf16 v[32:47], v[104:107], v[144:147], v[32:47]
    ds_read_b64_tr_b16 v[130:131], v222 offset:37888
    v_mfma_f32_32x32x16_bf16 v[80:95], v[104:107], v[148:151], v[80:95]
    ds_read_b128 v[168:171], v229 offset:32768
    ds_read_b64_tr_b16 v[132:133], v223 offset:37056
    s_waitcnt lgkmcnt(15)
    v_mfma_f32_32x32x16_bf16 v[0:15], v[108:111], v[152:155], v[0:15]
    ds_read_b64_tr_b16 v[134:135], v223 offset:37824
    ds_read_b128 v[172:175], v229 offset:36864
    s_waitcnt lgkmcnt(15)
    v_mfma_f32_32x32x16_bf16 v[48:63], v[108:111], v[156:159], v[48:63]
    ds_read_b64_tr_b16 v[136:137], v223 offset:37088
    s_waitcnt lgkmcnt(15)
    v_mfma_f32_32x32x16_bf16 v[16:31], v[112:115], v[152:155], v[16:31]
    ds_read_b64_tr_b16 v[138:139], v223 offset:37856
    ds_read_b64_tr_b16 v[140:141], v223 offset:37120
    v_mfma_f32_32x32x16_bf16 v[64:79], v[112:115], v[156:159], v[64:79]
    ds_read_b64_tr_b16 v[142:143], v223 offset:37888
    s_waitcnt lgkmcnt(15)
    v_mfma_f32_32x32x16_bf16 v[32:47], v[116:119], v[152:155], v[32:47]
    v_mfma_f32_32x32x16_bf16 v[80:95], v[116:119], v[156:159], v[80:95]
    s_waitcnt lgkmcnt(4)
    s_barrier
    s_waitcnt vmcnt(0)
    v_mfma_f32_32x32x16_bf16 v[0:15], v[120:123], v[160:163], v[0:15]
    ds_read_b128 v[144:147], v226 offset:0
    ds_read_b64_tr_b16 v[96:97], v224 offset:0
    v_mfma_f32_32x32x16_bf16 v[48:63], v[120:123], v[164:167], v[48:63]
    ds_read_b64_tr_b16 v[98:99], v224 offset:768
    ds_read_b128 v[148:151], v226 offset:4096
    v_mfma_f32_32x32x16_bf16 v[16:31], v[124:127], v[160:163], v[16:31]
    ds_read_b64_tr_b16 v[100:101], v224 offset:32
    v_mfma_f32_32x32x16_bf16 v[64:79], v[124:127], v[164:167], v[64:79]
    ds_read_b64_tr_b16 v[102:103], v224 offset:800
    ds_read_b64_tr_b16 v[104:105], v224 offset:64
    v_mfma_f32_32x32x16_bf16 v[32:47], v[128:131], v[160:163], v[32:47]
    ds_read_b64_tr_b16 v[106:107], v224 offset:832
    v_mfma_f32_32x32x16_bf16 v[80:95], v[128:131], v[164:167], v[80:95]
    ds_read_b128 v[152:155], v227 offset:0
    ds_read_b64_tr_b16 v[108:109], v225 offset:0
    v_mfma_f32_32x32x16_bf16 v[0:15], v[132:135], v[168:171], v[0:15]
    ds_read_b64_tr_b16 v[110:111], v225 offset:768
    ds_read_b128 v[156:159], v227 offset:4096
    v_mfma_f32_32x32x16_bf16 v[48:63], v[132:135], v[172:175], v[48:63]
    ds_read_b64_tr_b16 v[112:113], v225 offset:32
    s_waitcnt lgkmcnt(15)
    v_mfma_f32_32x32x16_bf16 v[16:31], v[136:139], v[168:171], v[16:31]
    ds_read_b64_tr_b16 v[114:115], v225 offset:800
    ds_read_b64_tr_b16 v[116:117], v225 offset:64
    v_mfma_f32_32x32x16_bf16 v[64:79], v[136:139], v[172:175], v[64:79]
    ds_read_b64_tr_b16 v[118:119], v225 offset:832
    s_waitcnt lgkmcnt(15)
    v_mfma_f32_32x32x16_bf16 v[32:47], v[140:143], v[168:171], v[32:47]
    v_mfma_f32_32x32x16_bf16 v[80:95], v[140:143], v[172:175], v[80:95]
    s_waitcnt lgkmcnt(13)
    v_mfma_f32_32x32x16_bf16 v[0:15], v[96:99], v[144:147], v[0:15]
    ds_read_b128 v[160:163], v228 offset:0
    ds_read_b64_tr_b16 v[120:121], v224 offset:12352
    s_waitcnt lgkmcnt(14)
    v_mfma_f32_32x32x16_bf16 v[48:63], v[96:99], v[148:151], v[48:63]
    ds_read_b64_tr_b16 v[122:123], v224 offset:13120
    ds_read_b128 v[164:167], v228 offset:4096
    s_waitcnt lgkmcnt(14)
    v_mfma_f32_32x32x16_bf16 v[16:31], v[100:103], v[144:147], v[16:31]
    ds_read_b64_tr_b16 v[124:125], v224 offset:12384
    v_mfma_f32_32x32x16_bf16 v[64:79], v[100:103], v[148:151], v[64:79]
    ds_read_b64_tr_b16 v[126:127], v224 offset:13152
    ds_read_b64_tr_b16 v[128:129], v224 offset:12416
    s_waitcnt lgkmcnt(15)
    v_mfma_f32_32x32x16_bf16 v[32:47], v[104:107], v[144:147], v[32:47]
    ds_read_b64_tr_b16 v[130:131], v224 offset:13184
    v_mfma_f32_32x32x16_bf16 v[80:95], v[104:107], v[148:151], v[80:95]
    ds_read_b128 v[168:171], v229 offset:0
    ds_read_b64_tr_b16 v[132:133], v225 offset:12352
    s_waitcnt lgkmcnt(15)
    v_mfma_f32_32x32x16_bf16 v[0:15], v[108:111], v[152:155], v[0:15]
    ds_read_b64_tr_b16 v[134:135], v225 offset:13120
    ds_read_b128 v[172:175], v229 offset:4096
    s_waitcnt lgkmcnt(15)
    v_mfma_f32_32x32x16_bf16 v[48:63], v[108:111], v[156:159], v[48:63]
    ds_read_b64_tr_b16 v[136:137], v225 offset:12384
    s_waitcnt lgkmcnt(15)
    v_mfma_f32_32x32x16_bf16 v[16:31], v[112:115], v[152:155], v[16:31]
    ds_read_b64_tr_b16 v[138:139], v225 offset:13152
    ds_read_b64_tr_b16 v[140:141], v225 offset:12416
    v_mfma_f32_32x32x16_bf16 v[64:79], v[112:115], v[156:159], v[64:79]
    ds_read_b64_tr_b16 v[142:143], v225 offset:13184
    s_waitcnt lgkmcnt(15)
    v_mfma_f32_32x32x16_bf16 v[32:47], v[116:119], v[152:155], v[32:47]
    v_mfma_f32_32x32x16_bf16 v[80:95], v[116:119], v[156:159], v[80:95]
    s_waitcnt lgkmcnt(4)
    s_barrier
    v_mfma_f32_32x32x16_bf16 v[0:15], v[120:123], v[160:163], v[0:15]
    ds_read_b128 v[144:147], v226 offset:16384
    ds_read_b64_tr_b16 v[96:97], v224 offset:24704
    v_mfma_f32_32x32x16_bf16 v[48:63], v[120:123], v[164:167], v[48:63]
    ds_read_b64_tr_b16 v[98:99], v224 offset:25472
    ds_read_b128 v[148:151], v226 offset:20480
    v_mfma_f32_32x32x16_bf16 v[16:31], v[124:127], v[160:163], v[16:31]
    ds_read_b64_tr_b16 v[100:101], v224 offset:24736
    v_mfma_f32_32x32x16_bf16 v[64:79], v[124:127], v[164:167], v[64:79]
    ds_read_b64_tr_b16 v[102:103], v224 offset:25504
    ds_read_b64_tr_b16 v[104:105], v224 offset:24768
    v_mfma_f32_32x32x16_bf16 v[32:47], v[128:131], v[160:163], v[32:47]
    ds_read_b64_tr_b16 v[106:107], v224 offset:25536
    v_mfma_f32_32x32x16_bf16 v[80:95], v[128:131], v[164:167], v[80:95]
    ds_read_b128 v[152:155], v227 offset:16384
    ds_read_b64_tr_b16 v[108:109], v225 offset:24704
    v_mfma_f32_32x32x16_bf16 v[0:15], v[132:135], v[168:171], v[0:15]
    ds_read_b64_tr_b16 v[110:111], v225 offset:25472
    ds_read_b128 v[156:159], v227 offset:20480
    v_mfma_f32_32x32x16_bf16 v[48:63], v[132:135], v[172:175], v[48:63]
    ds_read_b64_tr_b16 v[112:113], v225 offset:24736
    s_waitcnt lgkmcnt(15)
    v_mfma_f32_32x32x16_bf16 v[16:31], v[136:139], v[168:171], v[16:31]
    ds_read_b64_tr_b16 v[114:115], v225 offset:25504
    ds_read_b64_tr_b16 v[116:117], v225 offset:24768
    v_mfma_f32_32x32x16_bf16 v[64:79], v[136:139], v[172:175], v[64:79]
    ds_read_b64_tr_b16 v[118:119], v225 offset:25536
    s_waitcnt lgkmcnt(15)
    v_mfma_f32_32x32x16_bf16 v[32:47], v[140:143], v[168:171], v[32:47]
    v_mfma_f32_32x32x16_bf16 v[80:95], v[140:143], v[172:175], v[80:95]
    s_waitcnt lgkmcnt(13)
    v_mfma_f32_32x32x16_bf16 v[0:15], v[96:99], v[144:147], v[0:15]
    ds_read_b128 v[160:163], v228 offset:16384
    ds_read_b64_tr_b16 v[120:121], v224 offset:37056
    s_waitcnt lgkmcnt(14)
    v_mfma_f32_32x32x16_bf16 v[48:63], v[96:99], v[148:151], v[48:63]
    ds_read_b64_tr_b16 v[122:123], v224 offset:37824
    ds_read_b128 v[168:171], v229 offset:16384
    s_waitcnt lgkmcnt(14)
    v_mfma_f32_32x32x16_bf16 v[16:31], v[100:103], v[144:147], v[16:31]
    ds_read_b64_tr_b16 v[132:133], v225 offset:37056
    ds_read_b64_tr_b16 v[134:135], v225 offset:37824
    v_mfma_f32_32x32x16_bf16 v[64:79], v[100:103], v[148:151], v[64:79]
    ds_read_b128 v[164:167], v228 offset:20480
    ds_read_b128 v[172:175], v229 offset:20480
    s_waitcnt lgkmcnt(15)
    v_mfma_f32_32x32x16_bf16 v[32:47], v[104:107], v[144:147], v[32:47]
    ds_read_b64_tr_b16 v[124:125], v224 offset:37088
    ds_read_b64_tr_b16 v[126:127], v224 offset:37856
    v_mfma_f32_32x32x16_bf16 v[80:95], v[104:107], v[148:151], v[80:95]
    ds_read_b64_tr_b16 v[136:137], v225 offset:37088
    ds_read_b64_tr_b16 v[138:139], v225 offset:37856
    s_waitcnt lgkmcnt(15)
    v_mfma_f32_32x32x16_bf16 v[0:15], v[108:111], v[152:155], v[0:15]
    ds_read_b64_tr_b16 v[128:129], v224 offset:37120
    ds_read_b64_tr_b16 v[130:131], v224 offset:37888
    v_mfma_f32_32x32x16_bf16 v[48:63], v[108:111], v[156:159], v[48:63]
    ds_read_b64_tr_b16 v[140:141], v225 offset:37120
    ds_read_b64_tr_b16 v[142:143], v225 offset:37888
    s_waitcnt lgkmcnt(15)
    v_mfma_f32_32x32x16_bf16 v[16:31], v[112:115], v[152:155], v[16:31]
    s_lshl_b32 s30, s4, 2
    s_add_u32 s30, s30, 160928
    v_mov_b32 v176, s30
    v_mov_b32 v177, 1
    ds_write_b32 v176, v177
    v_and_b32 v240, 3, v230
    v_lshlrev_b32 v240, 2, v240
    v_add_u32 v240, 160944, v240
    s_mov_b32 s76, 0
L_sp_32:
    ds_read_b32 v241, v240
    s_waitcnt lgkmcnt(0)
    v_cmp_eq_u32 vcc, 0, v241
    s_cbranch_vccz L_spd_33
    s_sleep 1
    s_add_u32 s76, s76, 1
    s_cmp_lt_u32 s76, 1048576
    s_cbranch_scc1 L_sp_32
L_spd_33:
    ds_read_b64 v[188:189], v234 offset:0
    ds_read_b64 v[192:193], v234 offset:512
    ds_read_b64 v[196:197], v234 offset:1024
    ds_read_b128 v[212:215], v232 offset:0
    ds_read_b128 v[216:219], v232 offset:512
    ds_read_b64 v[236:237], v238
    s_lshl_b32 s30, s4, 2
    s_add_u32 s30, s30, 160992
    v_mov_b32 v178, s30
    v_mov_b32 v179, 1
    ds_write_b32 v178, v179
    v_mfma_f32_32x32x16_bf16 v[64:79], v[112:115], v[156:159], v[64:79]
    v_mfma_f32_32x32x16_bf16 v[32:47], v[116:119], v[152:155], v[32:47]
    v_mfma_f32_32x32x16_bf16 v[80:95], v[116:119], v[156:159], v[80:95]
    s_waitcnt lgkmcnt(1)
    v_mov_b32 v204, v215
    v_mov_b32 v205, v215
    v_mov_b32 v206, v215
    v_mov_b32 v207, v215
    v_mov_b32 v208, v219
    v_mov_b32 v209, v219
    v_mov_b32 v210, v219
    v_mov_b32 v211, v219
    v_readfirstlane_b32 s60, v236
    v_readfirstlane_b32 s61, v237
    v_mfma_f32_32x32x16_bf16 v[0:15], v[120:123], v[160:163], v[0:15]
    v_mfma_f32_32x32x16_bf16 v[0:15], v[132:135], v[168:171], v[0:15]
    v_mfma_f32_32x32x16_bf16 v[0:15], v[188:191], v[204:207], v[0:15]
    s_nop 11
    v_mul_f32 v240, v0, v0
    v_mul_f32 v241, v1, v1
    v_mul_f32 v242, v2, v2
    v_mul_f32 v243, v3, v3
    v_mul_f32 v244, v4, v4
    v_mfma_f32_32x32x16_bf16 v[48:63], v[120:123], v[164:167], v[48:63]
    v_mul_f32 v245, v5, v5
    v_mul_f32 v246, v6, v6
    v_mul_f32 v247, v7, v7
    v_fma_f32 v240, v240, v213, v212
    v_fma_f32 v241, v241, v213, v212
    v_mfma_f32_32x32x16_bf16 v[48:63], v[132:135], v[172:175], v[48:63]
    v_fma_f32 v242, v242, v213, v212
    v_fma_f32 v243, v243, v213, v212
    v_fma_f32 v244, v244, v213, v212
    v_fma_f32 v245, v245, v213, v212
    v_fma_f32 v246, v246, v213, v212
    v_mfma_f32_32x32x16_bf16 v[48:63], v[188:191], v[208:211], v[48:63]
    v_fma_f32 v247, v247, v213, v212
    v_mul_f32 v240, v240, v0
    v_mul_f32 v241, v241, v1
    v_mul_f32 v242, v242, v2
    v_mul_f32 v243, v243, v3
    v_mfma_f32_32x32x16_bf16 v[16:31], v[124:127], v[160:163], v[16:31]
    v_mul_f32 v244, v244, v4
    v_mul_f32 v245, v245, v5
    v_mul_f32 v246, v246, v6
    v_mul_f32 v247, v247, v7
    v_exp_f32 v240, v240
    v_mfma_f32_32x32x16_bf16 v[16:31], v[136:139], v[168:171], v[16:31]
    v_exp_f32 v241, v241
    v_exp_f32 v242, v242
    v_exp_f32 v243, v243
    v_mfma_f32_32x32x16_bf16 v[16:31], v[192:195], v[204:207], v[16:31]
    v_exp_f32 v244, v244
    v_exp_f32 v245, v245
    v_exp_f32 v246, v246
    v_mfma_f32_32x32x16_bf16 v[64:79], v[124:127], v[164:167], v[64:79]
    v_exp_f32 v247, v247
    v_mul_f32 v0, v0, v8
    v_mul_f32 v1, v1, v9
    v_mul_f32 v2, v2, v10
    v_mfma_f32_32x32x16_bf16 v[64:79], v[136:139], v[172:175], v[64:79]
    v_mul_f32 v3, v3, v11
    v_mul_f32 v4, v4, v12
    v_mul_f32 v5, v5, v13
    v_mul_f32 v6, v6, v14
    v_mul_f32 v7, v7, v15
    v_mfma_f32_32x32x16_bf16 v[64:79], v[192:195], v[208:211], v[64:79]
    v_fma_f32 v240, v240, v214, v214
    v_fma_f32 v241, v241, v214, v214
    v_fma_f32 v242, v242, v214, v214
    v_fma_f32 v243, v243, v214, v214
    v_fma_f32 v244, v244, v214, v214
    v_mfma_f32_32x32x16_bf16 v[32:47], v[128:131], v[160:163], v[32:47]
    v_fma_f32 v245, v245, v214, v214
    v_fma_f32 v246, v246, v214, v214
    v_fma_f32 v247, v247, v214, v214
    v_rcp_f32 v240, v240
    v_mfma_f32_32x32x16_bf16 v[32:47], v[140:143], v[168:171], v[32:47]
    v_rcp_f32 v241, v241
    v_rcp_f32 v242, v242
    v_rcp_f32 v243, v243
    v_mfma_f32_32x32x16_bf16 v[32:47], v[196:199], v[204:207], v[32:47]
    v_rcp_f32 v244, v244
    v_rcp_f32 v245, v245
    v_rcp_f32 v246, v246
    v_mfma_f32_32x32x16_bf16 v[80:95], v[128:131], v[164:167], v[80:95]
    v_rcp_f32 v247, v247
    s_nop 0
    v_mul_f32 v0, v0, v240
    v_mul_f32 v1, v1, v241
    v_mfma_f32_32x32x16_bf16 v[80:95], v[140:143], v[172:175], v[80:95]
    v_mul_f32 v2, v2, v242
    v_mul_f32 v3, v3, v243
    v_mul_f32 v4, v4, v244
    v_mul_f32 v5, v5, v245
    v_mul_f32 v6, v6, v246
    v_mfma_f32_32x32x16_bf16 v[80:95], v[196:199], v[208:211], v[80:95]
    v_mul_f32 v7, v7, v247
    v_cvt_pk_bf16_f32 v8, v0, v1
    v_cvt_pk_bf16_f32 v9, v2, v3
    v_cvt_pk_bf16_f32 v10, v4, v5
    v_cvt_pk_bf16_f32 v11, v6, v7
    buffer_store_dwordx4 v[8:11], v231, s[20:23], s34 offen offset:0 sc1
    v_pk_mul_f32 v[240:241], v[48:49], v[48:49]
    v_pk_mul_f32 v[242:243], v[50:51], v[50:51]
    v_pk_mul_f32 v[244:245], v[52:53], v[52:53]
    v_pk_mul_f32 v[246:247], v[54:55], v[54:55]
    v_pk_fma_f32 v[240:241], v[240:241], v[216:217], v[216:217] op_sel:[0,1,0] op_sel_hi:[1,1,0]
    v_pk_fma_f32 v[242:243], v[242:243], v[216:217], v[216:217] op_sel:[0,1,0] op_sel_hi:[1,1,0]
    v_pk_fma_f32 v[244:245], v[244:245], v[216:217], v[216:217] op_sel:[0,1,0] op_sel_hi:[1,1,0]
    v_pk_fma_f32 v[246:247], v[246:247], v[216:217], v[216:217] op_sel:[0,1,0] op_sel_hi:[1,1,0]
    v_pk_mul_f32 v[240:241], v[240:241], v[48:49]
    v_pk_mul_f32 v[242:243], v[242:243], v[50:51]
    v_pk_mul_f32 v[244:245], v[244:245], v[52:53]
    v_pk_mul_f32 v[246:247], v[246:247], v[54:55]
    v_exp_f32 v240, v240
    v_exp_f32 v241, v241
    v_exp_f32 v242, v242
    v_exp_f32 v243, v243
    v_exp_f32 v244, v244
    v_exp_f32 v245, v245
    v_exp_f32 v246, v246
    v_exp_f32 v247, v247
    v_pk_mul_f32 v[48:49], v[48:49], v[56:57]
    v_pk_mul_f32 v[50:51], v[50:51], v[58:59]
    v_pk_mul_f32 v[52:53], v[52:53], v[60:61]
    v_pk_mul_f32 v[54:55], v[54:55], v[62:63]
    v_pk_fma_f32 v[240:241], v[240:241], v[218:219], v[218:219] op_sel_hi:[1,0,0]
    v_pk_fma_f32 v[242:243], v[242:243], v[218:219], v[218:219] op_sel_hi:[1,0,0]
    v_pk_fma_f32 v[244:245], v[244:245], v[218:219], v[218:219] op_sel_hi:[1,0,0]
    v_pk_fma_f32 v[246:247], v[246:247], v[218:219], v[218:219] op_sel_hi:[1,0,0]
    v_rcp_f32 v240, v240
    v_rcp_f32 v241, v241
    v_rcp_f32 v242, v242
    v_rcp_f32 v243, v243
    v_rcp_f32 v244, v244
    v_rcp_f32 v245, v245
    v_rcp_f32 v246, v246
    v_rcp_f32 v247, v247
    s_nop 0
    v_pk_mul_f32 v[48:49], v[48:49], v[240:241]
    v_pk_mul_f32 v[50:51], v[50:51], v[242:243]
    v_pk_mul_f32 v[52:53], v[52:53], v[244:245]
    v_pk_mul_f32 v[54:55], v[54:55], v[246:247]
    v_cvt_pk_bf16_f32 v56, v48, v49
    v_cvt_pk_bf16_f32 v57, v50, v51
    v_cvt_pk_bf16_f32 v58, v52, v53
    v_cvt_pk_bf16_f32 v59, v54, v55
    buffer_store_dwordx4 v[56:59], v231, s[20:23], s33 offen offset:0 sc1
    v_pk_mul_f32 v[240:241], v[16:17], v[16:17]
    v_pk_mul_f32 v[242:243], v[18:19], v[18:19]
    v_pk_mul_f32 v[244:245], v[20:21], v[20:21]
    v_pk_mul_f32 v[246:247], v[22:23], v[22:23]
    v_pk_fma_f32 v[240:241], v[240:241], v[212:213], v[212:213] op_sel:[0,1,0] op_sel_hi:[1,1,0]
    v_pk_fma_f32 v[242:243], v[242:243], v[212:213], v[212:213] op_sel:[0,1,0] op_sel_hi:[1,1,0]
    v_pk_fma_f32 v[244:245], v[244:245], v[212:213], v[212:213] op_sel:[0,1,0] op_sel_hi:[1,1,0]
    v_pk_fma_f32 v[246:247], v[246:247], v[212:213], v[212:213] op_sel:[0,1,0] op_sel_hi:[1,1,0]
    v_pk_mul_f32 v[240:241], v[240:241], v[16:17]
    v_pk_mul_f32 v[242:243], v[242:243], v[18:19]
    v_pk_mul_f32 v[244:245], v[244:245], v[20:21]
    v_pk_mul_f32 v[246:247], v[246:247], v[22:23]
    v_exp_f32 v240, v240
    v_exp_f32 v241, v241
    v_exp_f32 v242, v242
    v_exp_f32 v243, v243
    v_exp_f32 v244, v244
    v_exp_f32 v245, v245
    v_exp_f32 v246, v246
    v_exp_f32 v247, v247
    v_pk_mul_f32 v[16:17], v[16:17], v[24:25]
    v_pk_mul_f32 v[18:19], v[18:19], v[26:27]
    v_pk_mul_f32 v[20:21], v[20:21], v[28:29]
    v_pk_mul_f32 v[22:23], v[22:23], v[30:31]
    v_pk_fma_f32 v[240:241], v[240:241], v[214:215], v[214:215] op_sel_hi:[1,0,0]
    v_pk_fma_f32 v[242:243], v[242:243], v[214:215], v[214:215] op_sel_hi:[1,0,0]
    v_pk_fma_f32 v[244:245], v[244:245], v[214:215], v[214:215] op_sel_hi:[1,0,0]
    v_pk_fma_f32 v[246:247], v[246:247], v[214:215], v[214:215] op_sel_hi:[1,0,0]
    v_rcp_f32 v240, v240
    v_rcp_f32 v241, v241
    v_rcp_f32 v242, v242
    v_rcp_f32 v243, v243
    v_rcp_f32 v244, v244
    v_rcp_f32 v245, v245
    v_rcp_f32 v246, v246
    v_rcp_f32 v247, v247
    s_nop 0
    v_pk_mul_f32 v[16:17], v[16:17], v[240:241]
    v_pk_mul_f32 v[18:19], v[18:19], v[242:243]
    v_pk_mul_f32 v[20:21], v[20:21], v[244:245]
    v_pk_mul_f32 v[22:23], v[22:23], v[246:247]
    v_cvt_pk_bf16_f32 v24, v16, v17
    v_cvt_pk_bf16_f32 v25, v18, v19
    v_cvt_pk_bf16_f32 v26, v20, v21
    v_cvt_pk_bf16_f32 v27, v22, v23
    buffer_store_dwordx4 v[24:27], v231, s[20:23], s34 offen offset:1024 sc1
    v_pk_mul_f32 v[240:241], v[64:65], v[64:65]
    v_pk_mul_f32 v[242:243], v[66:67], v[66:67]
    v_pk_mul_f32 v[244:245], v[68:69], v[68:69]
    v_pk_mul_f32 v[246:247], v[70:71], v[70:71]
    v_pk_fma_f32 v[240:241], v[240:241], v[216:217], v[216:217] op_sel:[0,1,0] op_sel_hi:[1,1,0]
    v_pk_fma_f32 v[242:243], v[242:243], v[216:217], v[216:217] op_sel:[0,1,0] op_sel_hi:[1,1,0]
    v_pk_fma_f32 v[244:245], v[244:245], v[216:217], v[216:217] op_sel:[0,1,0] op_sel_hi:[1,1,0]
    v_pk_fma_f32 v[246:247], v[246:247], v[216:217], v[216:217] op_sel:[0,1,0] op_sel_hi:[1,1,0]
    v_pk_mul_f32 v[240:241], v[240:241], v[64:65]
    v_pk_mul_f32 v[242:243], v[242:243], v[66:67]
    v_pk_mul_f32 v[244:245], v[244:245], v[68:69]
    v_pk_mul_f32 v[246:247], v[246:247], v[70:71]
    v_exp_f32 v240, v240
    v_exp_f32 v241, v241
    v_exp_f32 v242, v242
    v_exp_f32 v243, v243
    v_exp_f32 v244, v244
    v_exp_f32 v245, v245
    v_exp_f32 v246, v246
    v_exp_f32 v247, v247
    v_pk_mul_f32 v[64:65], v[64:65], v[72:73]
    v_pk_mul_f32 v[66:67], v[66:67], v[74:75]
    v_pk_mul_f32 v[68:69], v[68:69], v[76:77]
    v_pk_mul_f32 v[70:71], v[70:71], v[78:79]
    v_pk_fma_f32 v[240:241], v[240:241], v[218:219], v[218:219] op_sel_hi:[1,0,0]
    v_pk_fma_f32 v[242:243], v[242:243], v[218:219], v[218:219] op_sel_hi:[1,0,0]
    v_pk_fma_f32 v[244:245], v[244:245], v[218:219], v[218:219] op_sel_hi:[1,0,0]
    v_pk_fma_f32 v[246:247], v[246:247], v[218:219], v[218:219] op_sel_hi:[1,0,0]
    v_rcp_f32 v240, v240
    v_rcp_f32 v241, v241
    v_rcp_f32 v242, v242
    v_rcp_f32 v243, v243
    v_rcp_f32 v244, v244
    v_rcp_f32 v245, v245
    v_rcp_f32 v246, v246
    v_rcp_f32 v247, v247
    s_nop 0
    v_pk_mul_f32 v[64:65], v[64:65], v[240:241]
    v_pk_mul_f32 v[66:67], v[66:67], v[242:243]
    v_pk_mul_f32 v[68:69], v[68:69], v[244:245]
    v_pk_mul_f32 v[70:71], v[70:71], v[246:247]
    v_cvt_pk_bf16_f32 v72, v64, v65
    v_cvt_pk_bf16_f32 v73, v66, v67
    v_cvt_pk_bf16_f32 v74, v68, v69
    v_cvt_pk_bf16_f32 v75, v70, v71
    buffer_store_dwordx4 v[72:75], v231, s[20:23], s33 offen offset:1024 sc1
    v_pk_mul_f32 v[240:241], v[32:33], v[32:33]
    v_pk_mul_f32 v[242:243], v[34:35], v[34:35]
    v_pk_mul_f32 v[244:245], v[36:37], v[36:37]
    v_pk_mul_f32 v[246:247], v[38:39], v[38:39]
    v_pk_fma_f32 v[240:241], v[240:241], v[212:213], v[212:213] op_sel:[0,1,0] op_sel_hi:[1,1,0]
    v_pk_fma_f32 v[242:243], v[242:243], v[212:213], v[212:213] op_sel:[0,1,0] op_sel_hi:[1,1,0]
    v_pk_fma_f32 v[244:245], v[244:245], v[212:213], v[212:213] op_sel:[0,1,0] op_sel_hi:[1,1,0]
    v_pk_fma_f32 v[246:247], v[246:247], v[212:213], v[212:213] op_sel:[0,1,0] op_sel_hi:[1,1,0]
    v_pk_mul_f32 v[240:241], v[240:241], v[32:33]
    v_pk_mul_f32 v[242:243], v[242:243], v[34:35]
    v_pk_mul_f32 v[244:245], v[244:245], v[36:37]
    v_pk_mul_f32 v[246:247], v[246:247], v[38:39]
    v_exp_f32 v240, v240
    v_exp_f32 v241, v241
    v_exp_f32 v242, v242
    v_exp_f32 v243, v243
    v_exp_f32 v244, v244
    v_exp_f32 v245, v245
    v_exp_f32 v246, v246
    v_exp_f32 v247, v247
    v_pk_mul_f32 v[32:33], v[32:33], v[40:41]
    v_pk_mul_f32 v[34:35], v[34:35], v[42:43]
    v_pk_mul_f32 v[36:37], v[36:37], v[44:45]
    v_pk_mul_f32 v[38:39], v[38:39], v[46:47]
    v_pk_fma_f32 v[240:241], v[240:241], v[214:215], v[214:215] op_sel_hi:[1,0,0]
    v_pk_fma_f32 v[242:243], v[242:243], v[214:215], v[214:215] op_sel_hi:[1,0,0]
    v_pk_fma_f32 v[244:245], v[244:245], v[214:215], v[214:215] op_sel_hi:[1,0,0]
    v_pk_fma_f32 v[246:247], v[246:247], v[214:215], v[214:215] op_sel_hi:[1,0,0]
    v_rcp_f32 v240, v240
    v_rcp_f32 v241, v241
    v_rcp_f32 v242, v242
    v_rcp_f32 v243, v243
    v_rcp_f32 v244, v244
    v_rcp_f32 v245, v245
    v_rcp_f32 v246, v246
    v_rcp_f32 v247, v247
    s_nop 0
    v_pk_mul_f32 v[32:33], v[32:33], v[240:241]
    v_pk_mul_f32 v[34:35], v[34:35], v[242:243]
    v_pk_mul_f32 v[36:37], v[36:37], v[244:245]
    v_pk_mul_f32 v[38:39], v[38:39], v[246:247]
    v_cvt_pk_bf16_f32 v40, v32, v33
    v_cvt_pk_bf16_f32 v41, v34, v35
    v_cvt_pk_bf16_f32 v42, v36, v37
    v_cvt_pk_bf16_f32 v43, v38, v39
    buffer_store_dwordx4 v[40:43], v231, s[20:23], s36 offen offset:0 sc1
    s_lshl_b32 s30, s4, 2
    s_add_u32 s30, s30, 160896
    v_mov_b32 v176, s30
    v_mov_b32 v177, 1
    ds_write_b32 v176, v177
    v_pk_mul_f32 v[240:241], v[80:81], v[80:81]
    v_pk_mul_f32 v[242:243], v[82:83], v[82:83]
    v_pk_mul_f32 v[244:245], v[84:85], v[84:85]
    v_pk_mul_f32 v[246:247], v[86:87], v[86:87]
    v_pk_fma_f32 v[240:241], v[240:241], v[216:217], v[216:217] op_sel:[0,1,0] op_sel_hi:[1,1,0]
    v_pk_fma_f32 v[242:243], v[242:243], v[216:217], v[216:217] op_sel:[0,1,0] op_sel_hi:[1,1,0]
    v_pk_fma_f32 v[244:245], v[244:245], v[216:217], v[216:217] op_sel:[0,1,0] op_sel_hi:[1,1,0]
    v_pk_fma_f32 v[246:247], v[246:247], v[216:217], v[216:217] op_sel:[0,1,0] op_sel_hi:[1,1,0]
    v_pk_mul_f32 v[240:241], v[240:241], v[80:81]
    v_pk_mul_f32 v[242:243], v[242:243], v[82:83]
    v_pk_mul_f32 v[244:245], v[244:245], v[84:85]
    v_pk_mul_f32 v[246:247], v[246:247], v[86:87]
    v_exp_f32 v240, v240
    v_exp_f32 v241, v241
    v_exp_f32 v242, v242
    v_exp_f32 v243, v243
    v_exp_f32 v244, v244
    v_exp_f32 v245, v245
    v_exp_f32 v246, v246
    v_exp_f32 v247, v247
    v_pk_mul_f32 v[80:81], v[80:81], v[88:89]
    v_pk_mul_f32 v[82:83], v[82:83], v[90:91]
    v_pk_mul_f32 v[84:85], v[84:85], v[92:93]
    v_pk_mul_f32 v[86:87], v[86:87], v[94:95]
    v_pk_fma_f32 v[240:241], v[240:241], v[218:219], v[218:219] op_sel_hi:[1,0,0]
    v_pk_fma_f32 v[242:243], v[242:243], v[218:219], v[218:219] op_sel_hi:[1,0,0]
    v_pk_fma_f32 v[244:245], v[244:245], v[218:219], v[218:219] op_sel_hi:[1,0,0]
    v_pk_fma_f32 v[246:247], v[246:247], v[218:219], v[218:219] op_sel_hi:[1,0,0]
    v_rcp_f32 v240, v240
    v_rcp_f32 v241, v241
    v_rcp_f32 v242, v242
    v_rcp_f32 v243, v243
    v_rcp_f32 v244, v244
    v_rcp_f32 v245, v245
    v_rcp_f32 v246, v246
    v_rcp_f32 v247, v247
    s_nop 0
    v_pk_mul_f32 v[80:81], v[80:81], v[240:241]
    v_pk_mul_f32 v[82:83], v[82:83], v[242:243]
    v_pk_mul_f32 v[84:85], v[84:85], v[244:245]
    v_pk_mul_f32 v[86:87], v[86:87], v[246:247]
    v_cvt_pk_bf16_f32 v88, v80, v81
    v_cvt_pk_bf16_f32 v89, v82, v83
    v_cvt_pk_bf16_f32 v90, v84, v85
    v_cvt_pk_bf16_f32 v91, v86, v87
    buffer_store_dwordx4 v[88:91], v231, s[20:23], s38 offen offset:0 sc1
    v_mov_b32 v240, 160776
    v_mov_b32 v241, 1
    s_waitcnt vmcnt(2)
    s_mov_b64 exec, 1
    ds_add_rtn_u32 v242, v240, v241
    s_mov_b64 exec, -1
    s_waitcnt lgkmcnt(0)
    v_readfirstlane_b32 s55, v242
    s_cmp_lg_u32 s55, 3
    s_cbranch_scc1 L_n0_34
    v_lshl_add_u32 v241, v230, 3, s35
    v_mov_b32 v242, s60
    v_mov_b32 v243, s61
    s_mov_b64 exec, 0xffff
    global_store_dwordx2 v241, v[242:243], s[10:11] sc1
    s_mov_b64 exec, -1
L_n0_34:
K_B:
    s_setprio 0
    s_add_u32 s35, s35, 2048
    s_lshl_b32 s77, s49, 3
    s_add_u32 s30, s77, 160816
    v_and_b32 v240, 1, v230
    v_lshlrev_b32 v240, 2, v240
    v_add_u32 v240, s30, v240
    s_mov_b32 s76, 0
L_sp_35:
    ds_read_b32 v241, v240
    s_waitcnt lgkmcnt(0)
    v_cmp_eq_u32 vcc, 0, v241
    s_cbranch_vccz L_spd_36
    s_sleep 1
    s_add_u32 s76, s76, 1
    s_cmp_lt_u32 s76, 1048576
    s_cbranch_scc1 L_sp_35
L_spd_36:
    ds_read_b64_tr_b16 v[0:1], v250 offset:0
    ds_read_b64_tr_b16 v[2:3], v250 offset:1024
    ds_read_b64_tr_b16 v[4:5], v251 offset:0
    ds_read_b64_tr_b16 v[6:7], v251 offset:1024
    ds_read_b64_tr_b16 v[12:13], v250 offset:4096
    ds_read_b64_tr_b16 v[14:15], v250 offset:5120
    ds_read_b64_tr_b16 v[16:17], v251 offset:4096
    ds_read_b64_tr_b16 v[18:19], v251 offset:5120
    ds_read_b64_tr_b16 v[20:21], v250 offset:8192
    ds_read_b64_tr_b16 v[22:23], v250 offset:9216
    ds_read_b64_tr_b16 v[28:29], v251 offset:8192
    ds_read_b64_tr_b16 v[30:31], v251 offset:9216
    ds_read_b64_tr_b16 v[32:33], v250 offset:12288
    ds_read_b64_tr_b16 v[34:35], v250 offset:13312
    ds_read_b64_tr_b16 v[36:37], v251 offset:12288
    ds_read_b64_tr_b16 v[38:39], v251 offset:13312
    ds_read_b64_tr_b16 v[44:45], v250 offset:16384
    ds_read_b64_tr_b16 v[46:47], v250 offset:17408
    ds_read_b64_tr_b16 v[48:49], v251 offset:16384
    ds_read_b64_tr_b16 v[50:51], v251 offset:17408
    ds_read_b64_tr_b16 v[52:53], v250 offset:20480
    ds_read_b64_tr_b16 v[54:55], v250 offset:21504
    ds_read_b64_tr_b16 v[60:61], v251 offset:20480
    ds_read_b64_tr_b16 v[62:63], v251 offset:21504
    ds_read_b64_tr_b16 v[64:65], v250 offset:24576
    ds_read_b64_tr_b16 v[66:67], v250 offset:25600
    ds_read_b64_tr_b16 v[68:69], v251 offset:24576
    ds_read_b64_tr_b16 v[70:71], v251 offset:25600
    s_lshl_b32 s30, s4, 2
    s_add_u32 s30, s30, 160848
    v_mov_b32 v240, s30
    v_mov_b32 v241, 1
    ds_write_b32 v240, v241
    s_add_u32 s30, s77, 160848
    v_and_b32 v240, 1, v230
    v_lshlrev_b32 v240, 2, v240
    v_add_u32 v240, s30, v240
    s_mov_b32 s76, 0
L_sp_37:
    ds_read_b32 v241, v240
    s_waitcnt lgkmcnt(0)
    v_cmp_eq_u32 vcc, 0, v241
    s_cbranch_vccz L_spd_38
    s_sleep 1
    s_add_u32 s76, s76, 1
    s_cmp_lt_u32 s76, 1048576
    s_cbranch_scc1 L_sp_37
L_spd_38:
    s_add_u32 m0, s53, 49152
    s_nop 0
    buffer_load_dwordx4 v235, s[64:67], s5 offen lds
    s_add_u32 m0, s53, 53248
    s_nop 0
    buffer_load_dwordx4 v235, s[64:67], s8 offen lds
    v_mov_b32 v240, 160768
    v_mov_b32 v241, 1
    s_waitcnt vmcnt(2)
    s_mov_b64 exec, 1
    ds_add_rtn_u32 v242, v240, v241
    s_mov_b64 exec, -1
    s_waitcnt lgkmcnt(0)
    v_readfirstlane_b32 s55, v242
    s_cmp_lg_u32 s55, 3
    s_cbranch_scc1 L_nl_39
    v_lshl_add_u32 v241, v230, 3, s35
    v_mov_b32 v242, s60
    v_mov_b32 v243, s61
    s_mov_b64 exec, 0xffff
    global_store_dwordx2 v241, v[242:243], s[10:11] sc1
    s_mov_b64 exec, -1
L_nl_39:
    s_add_u32 m0, s53, 57344
    s_nop 0
    buffer_load_dwordx4 v235, s[64:67], s9 offen lds
    s_waitcnt vmcnt(2)
    s_add_u32 m0, s53, 61440
    s_nop 0
    buffer_load_dwordx4 v235, s[64:67], s39 offen lds
    s_waitcnt vmcnt(2)
    s_add_u32 m0, s53, 65536
    s_nop 0
    buffer_load_dwordx4 v235, s[64:67], s40 offen lds
    s_waitcnt vmcnt(2)
    s_add_u32 m0, s53, 69632
    s_nop 0
    buffer_load_dwordx4 v235, s[64:67], s41 offen lds
    s_waitcnt vmcnt(2)
    s_add_u32 m0, s53, 73728
    s_nop 0
    buffer_load_dwordx4 v235, s[64:67], s42 offen lds
    s_lshl_b32 s30, s48, 13
    s_add_u32 s30, s30, 126976
    s_lshl_b32 s31, s49, 11
    s_add_u32 s33, s31, s30
    v_add_u32 v210, s33, v231
    s_xor_b32 s31, s31, 0x800
    s_add_u32 s33, s31, s30
    v_add_u32 v211, s33, v231
    s_lshl_b32 s30, s4, 2
    s_add_u32 s30, s30, 160800
    v_mov_b32 v228, s30
    v_xor_b32 v229, 8, v228
    s_mul_i32 s31, s48, 4608
    s_add_u32 s31, s31, 110592
    v_and_b32 v244, 31, v230
    v_mul_u32_u24 v244, 144, v244
    v_lshrrev_b32 v245, 5, v230
    v_lshl_add_u32 v244, v245, 5, v244
    s_add_u32 s34, s31, s37
    v_add_u32 v236, s34, v244
    v_lshrrev_b32 v244, 2, v230
    v_and_b32 v245, 3, v230
    s_mov_b32 s33, s27
    v_lshlrev_b32 v245, 4, v245
    v_mul_u32_u24 v246, 144, v244
    v_add3_u32 v237, v246, v245, s34
    v_lshl_add_u32 v238, v244, 16, v245
    s_add_u32 s34, s33, 1048576
    s_cmp_lg_u32 s4, 2
    s_cbranch_scc1 L_np_40
    s_mov_b32 s76, 0
L_fp_41:
    global_load_dwordx2 v[208:209], v220, s[10:11] sc1
    s_waitcnt vmcnt(0)
    v_cmp_ne_u64 vcc, s[60:61], v[208:209]
    s_cbranch_vccz L_fpd_42
    s_mov_b64 exec, vcc
    s_sleep 4
    s_add_u32 s76, s76, 1
    s_cmp_lt_u32 s76, 1048576
    s_cbranch_scc1 L_fp_41
L_fpd_42:
    s_mov_b64 exec, -1
    v_mov_b32 v240, 160772
    v_mov_b32 v241, 1
    ds_write_b32 v240, v241
L_np_40:
    v_and_b32 v240, 0, v230
    v_lshlrev_b32 v240, 2, v240
    v_add_u32 v240, 160772, v240
    s_mov_b32 s76, 0
L_sp_43:
    ds_read_b32 v241, v240
    s_waitcnt lgkmcnt(0)
    v_cmp_eq_u32 vcc, 0, v241
    s_cbranch_vccz L_spd_44
    s_sleep 1
    s_add_u32 s76, s76, 1
    s_cmp_lt_u32 s76, 1048576
    s_cbranch_scc1 L_sp_43
L_spd_44:
    s_lshl_b32 s28, s72, 10
    buffer_load_dwordx4 v[76:79], v239, s[20:23], s28 offen offset:0 sc1
    buffer_load_dwordx4 v[80:83], v239, s[20:23], s28 offen offset:1024 sc1
    buffer_load_dwordx4 v[84:87], v239, s[20:23], s28 offen offset:2048 sc1
    buffer_load_dwordx4 v[92:95], v239, s[20:23], s28 offen offset:3072 sc1
    s_add_u32 s28, s28, 4096
    s_and_b32 s28, s28, 0x7fff
    buffer_load_dwordx4 v[96:99], v239, s[20:23], s28 offen offset:0 sc1
    buffer_load_dwordx4 v[100:103], v239, s[20:23], s28 offen offset:1024 sc1
    buffer_load_dwordx4 v[104:107], v239, s[20:23], s28 offen offset:2048 sc1
    buffer_load_dwordx4 v[108:111], v239, s[20:23], s28 offen offset:3072 sc1
    s_add_u32 s28, s28, 4096
    s_and_b32 s28, s28, 0x7fff
    buffer_load_dwordx4 v[112:115], v239, s[20:23], s28 offen offset:0 sc1
    buffer_load_dwordx4 v[116:119], v239, s[20:23], s28 offen offset:1024 sc1
    v_lshlrev_b32 v232, 2, v230
    v_add_u32 v232, 160768, v232
    s_lshl_b32 s3, s49, 1
    s_lshl_b32 s3, 3, s3
    s_waitcnt vmcnt(9)
    v_mfma_f32_32x32x16_bf16 v[136:151], v[0:3], v[76:79], 0
    v_mfma_f32_32x32x16_bf16 v[152:167], v[4:7], v[76:79], 0
    buffer_load_dwordx4 v[120:123], v239, s[20:23], s28 offen offset:2048 sc1
    s_waitcnt vmcnt(9)
    v_mfma_f32_32x32x16_bf16 v[136:151], v[12:15], v[80:83], v[136:151]
    v_mfma_f32_32x32x16_bf16 v[152:167], v[16:19], v[80:83], v[152:167]
    buffer_load_dwordx4 v[124:127], v239, s[20:23], s28 offen offset:3072 sc1
    s_lshl_b32 s30, s4, 2
    s_add_u32 s30, s30, 160864
    v_mov_b32 v240, s30
    v_mov_b32 v241, 1
    ds_write_b32 v240, v241
    s_waitcnt vmcnt(9)
    v_mfma_f32_32x32x16_bf16 v[136:151], v[20:23], v[84:87], v[136:151]
    v_mfma_f32_32x32x16_bf16 v[152:167], v[28:31], v[84:87], v[152:167]
    s_add_u32 s28, s28, 4096
    s_and_b32 s28, s28, 0x7fff
    buffer_load_dwordx4 v[128:131], v239, s[20:23], s28 offen offset:0 sc1
    s_waitcnt vmcnt(9)
    ds_read_b32 v233, v232
    v_mfma_f32_32x32x16_bf16 v[136:151], v[32:35], v[92:95], v[136:151]
    v_mfma_f32_32x32x16_bf16 v[152:167], v[36:39], v[92:95], v[152:167]
    buffer_load_dwordx4 v[132:135], v239, s[20:23], s28 offen offset:1024 sc1
    s_waitcnt vmcnt(9)
    v_mfma_f32_32x32x16_bf16 v[136:151], v[44:47], v[96:99], v[136:151]
    s_waitcnt lgkmcnt(0)
    v_cmp_eq_u32 vcc, 0, v233
    s_lshl_b32 s30, s3, 16
    s_and_b32 s30, s30, vcc_lo
    s_cbranch_scc0 L_ck_45
    s_add_u32 s30, s77, 160832
    v_and_b32 v240, 1, v230
    v_lshlrev_b32 v240, 2, v240
    v_add_u32 v240, s30, v240
    s_mov_b32 s76, 0
L_sp_46:
    ds_read_b32 v241, v240
    s_waitcnt lgkmcnt(0)
    v_cmp_eq_u32 vcc, 0, v241
    s_cbranch_vccz L_spd_47
    s_sleep 1
    s_add_u32 s76, s76, 1
    s_cmp_lt_u32 s76, 1048576
    s_cbranch_scc1 L_sp_46
L_spd_47:
L_ck_45:
    ds_read_b64_tr_b16 v[184:185], v250 offset:28672
    ds_read_b64_tr_b16 v[186:187], v250 offset:29696
    ds_read_b64_tr_b16 v[188:189], v251 offset:28672
    ds_read_b64_tr_b16 v[190:191], v251 offset:29696
    v_mfma_f32_32x32x16_bf16 v[152:167], v[48:51], v[96:99], v[152:167]
    buffer_load_dwordx4 v[192:195], v239, s[20:23], s28 offen offset:2048 sc1
    s_waitcnt vmcnt(9)
    v_mfma_f32_32x32x16_bf16 v[136:151], v[52:55], v[100:103], v[136:151]
    ds_read_b64_tr_b16 v[196:197], v250 offset:45056
    ds_read_b64_tr_b16 v[198:199], v250 offset:46080
    ds_read_b64_tr_b16 v[212:213], v251 offset:45056
    ds_read_b64_tr_b16 v[214:215], v251 offset:46080
    v_mfma_f32_32x32x16_bf16 v[152:167], v[60:63], v[100:103], v[152:167]
    buffer_load_dwordx4 v[216:219], v239, s[20:23], s28 offen offset:3072 sc1
    s_waitcnt vmcnt(9)
    v_mfma_f32_32x32x16_bf16 v[136:151], v[64:67], v[104:107], v[136:151]
    ds_read_b64_tr_b16 v[224:225], v252 offset:0
    ds_read_b64_tr_b16 v[226:227], v252 offset:1024
    ds_read_b64_tr_b16 v[8:9], v253 offset:0
    ds_read_b64_tr_b16 v[10:11], v253 offset:1024
    v_mfma_f32_32x32x16_bf16 v[152:167], v[68:71], v[104:107], v[152:167]
    s_add_u32 s28, s28, 4096
    s_and_b32 s28, s28, 0x7fff
    buffer_load_dwordx4 v[24:27], v239, s[20:23], s28 offen offset:0 sc1
    s_waitcnt vmcnt(9) lgkmcnt(8)
    v_mfma_f32_32x32x16_bf16 v[136:151], v[184:187], v[108:111], v[136:151]
    ds_read_b64_tr_b16 v[40:41], v252 offset:4096
    ds_read_b64_tr_b16 v[42:43], v252 offset:5120
    ds_read_b64_tr_b16 v[56:57], v253 offset:4096
    ds_read_b64_tr_b16 v[58:59], v253 offset:5120
    v_mfma_f32_32x32x16_bf16 v[152:167], v[188:191], v[108:111], v[152:167]
    buffer_load_dwordx4 v[72:75], v239, s[20:23], s28 offen offset:1024 sc1
    s_waitcnt vmcnt(9) lgkmcnt(8)
    v_mfma_f32_32x32x16_bf16 v[136:151], v[196:199], v[112:115], v[136:151]
    ds_read_b64_tr_b16 v[88:89], v252 offset:8192
    ds_read_b64_tr_b16 v[90:91], v252 offset:9216
    ds_read_b64_tr_b16 v[0:1], v253 offset:8192
    ds_read_b64_tr_b16 v[2:3], v253 offset:9216
    v_mfma_f32_32x32x16_bf16 v[152:167], v[212:215], v[112:115], v[152:167]
    buffer_load_dwordx4 v[4:7], v239, s[20:23], s28 offen offset:2048 sc1
    s_waitcnt vmcnt(9) lgkmcnt(8)
    v_mfma_f32_32x32x16_bf16 v[136:151], v[224:227], v[116:119], v[136:151]
    ds_read_b64_tr_b16 v[76:77], v252 offset:12288
    ds_read_b64_tr_b16 v[78:79], v252 offset:13312
    ds_read_b64_tr_b16 v[12:13], v253 offset:12288
    ds_read_b64_tr_b16 v[14:15], v253 offset:13312
    v_mfma_f32_32x32x16_bf16 v[152:167], v[8:11], v[116:119], v[152:167]
    buffer_load_dwordx4 v[16:19], v239, s[20:23], s28 offen offset:3072 sc1
    s_waitcnt vmcnt(9) lgkmcnt(8)
    v_mfma_f32_32x32x16_bf16 v[136:151], v[40:43], v[120:123], v[136:151]
    ds_read_b64_tr_b16 v[80:81], v252 offset:16384
    ds_read_b64_tr_b16 v[82:83], v252 offset:17408
    ds_read_b64_tr_b16 v[20:21], v253 offset:16384
    ds_read_b64_tr_b16 v[22:23], v253 offset:17408
    v_mfma_f32_32x32x16_bf16 v[152:167], v[56:59], v[120:123], v[152:167]
    s_add_u32 s28, s28, 4096
    s_and_b32 s28, s28, 0x7fff
    buffer_load_dwordx4 v[28:31], v239, s[20:23], s28 offen offset:0 sc1
    s_waitcnt vmcnt(9) lgkmcnt(8)
    v_mfma_f32_32x32x16_bf16 v[136:151], v[88:91], v[124:127], v[136:151]
    ds_read_b64_tr_b16 v[84:85], v252 offset:20480
    ds_read_b64_tr_b16 v[86:87], v252 offset:21504
    ds_read_b64_tr_b16 v[32:33], v253 offset:20480
    ds_read_b64_tr_b16 v[34:35], v253 offset:21504
    v_mfma_f32_32x32x16_bf16 v[152:167], v[0:3], v[124:127], v[152:167]
    buffer_load_dwordx4 v[36:39], v239, s[20:23], s28 offen offset:1024 sc1
    s_waitcnt vmcnt(9) lgkmcnt(8)
    v_mfma_f32_32x32x16_bf16 v[136:151], v[76:79], v[128:131], v[136:151]
    ds_read_b64_tr_b16 v[92:93], v252 offset:24576
    ds_read_b64_tr_b16 v[94:95], v252 offset:25600
    ds_read_b64_tr_b16 v[44:45], v253 offset:24576
    ds_read_b64_tr_b16 v[46:47], v253 offset:25600
    v_mfma_f32_32x32x16_bf16 v[152:167], v[12:15], v[128:131], v[152:167]
    buffer_load_dwordx4 v[48:51], v239, s[20:23], s28 offen offset:2048 sc1
    s_waitcnt vmcnt(9) lgkmcnt(8)
    v_mfma_f32_32x32x16_bf16 v[136:151], v[80:83], v[132:135], v[136:151]
    ds_read_b64_tr_b16 v[96:97], v252 offset:28672
    ds_read_b64_tr_b16 v[98:99], v252 offset:29696
    ds_read_b64_tr_b16 v[52:53], v253 offset:28672
    ds_read_b64_tr_b16 v[54:55], v253 offset:29696
    v_mfma_f32_32x32x16_bf16 v[152:167], v[20:23], v[132:135], v[152:167]
    buffer_load_dwordx4 v[60:63], v239, s[20:23], s28 offen offset:3072 sc1
    s_waitcnt vmcnt(9) lgkmcnt(8)
    v_mfma_f32_32x32x16_bf16 v[136:151], v[84:87], v[192:195], v[136:151]
    ds_read_b64_tr_b16 v[100:101], v252 offset:32768
    ds_read_b64_tr_b16 v[102:103], v252 offset:33792
    ds_read_b64_tr_b16 v[64:65], v253 offset:32768
    ds_read_b64_tr_b16 v[66:67], v253 offset:33792
    v_mfma_f32_32x32x16_bf16 v[152:167], v[32:35], v[192:195], v[152:167]
    v_and_b32 v244, 7, v230
    s_lshl_b32 s30, s49, 10
    s_add_u32 s30, s30, s50
    v_lshl_add_u32 v220, v244, 7, s30
    global_load_dwordx2 v[208:209], v220, s[10:11] offset:2048 sc1
    s_add_u32 s28, s28, 4096
    s_and_b32 s28, s28, 0x7fff
    buffer_load_dwordx4 v[68:71], v239, s[20:23], s28 offen offset:0 sc1
    s_waitcnt vmcnt(10) lgkmcnt(8)
    v_mfma_f32_32x32x16_bf16 v[136:151], v[92:95], v[216:219], v[136:151]
    ds_read_b64_tr_b16 v[104:105], v252 offset:36864
    ds_read_b64_tr_b16 v[106:107], v252 offset:37888
    ds_read_b64_tr_b16 v[184:185], v253 offset:36864
    ds_read_b64_tr_b16 v[186:187], v253 offset:37888
    v_mfma_f32_32x32x16_bf16 v[152:167], v[44:47], v[216:219], v[152:167]
    buffer_load_dwordx4 v[188:191], v239, s[20:23], s28 offen offset:1024 sc1
    s_waitcnt vmcnt(10) lgkmcnt(8)
    v_mfma_f32_32x32x16_bf16 v[136:151], v[96:99], v[24:27], v[136:151]
    ds_read_b64_tr_b16 v[108:109], v252 offset:40960
    ds_read_b64_tr_b16 v[110:111], v252 offset:41984
    ds_read_b64_tr_b16 v[196:197], v253 offset:40960
    ds_read_b64_tr_b16 v[198:199], v253 offset:41984
    v_mfma_f32_32x32x16_bf16 v[152:167], v[52:55], v[24:27], v[152:167]
    buffer_load_dwordx4 v[212:215], v239, s[20:23], s28 offen offset:2048 sc1
    s_waitcnt vmcnt(10) lgkmcnt(8)
    v_mfma_f32_32x32x16_bf16 v[136:151], v[100:103], v[72:75], v[136:151]
    ds_read_b64_tr_b16 v[112:113], v252 offset:45056
    ds_read_b64_tr_b16 v[114:115], v252 offset:46080
    ds_read_b64_tr_b16 v[224:225], v253 offset:45056
    ds_read_b64_tr_b16 v[226:227], v253 offset:46080
    v_mfma_f32_32x32x16_bf16 v[152:167], v[64:67], v[72:75], v[152:167]
    buffer_load_dwordx4 v[8:11], v239, s[20:23], s28 offen offset:3072 sc1
    s_waitcnt vmcnt(10) lgkmcnt(8)
    v_mfma_f32_32x32x16_bf16 v[136:151], v[104:107], v[4:7], v[136:151]
    ds_read_b64_tr_b16 v[116:117], v248 offset:16384
    ds_read_b64_tr_b16 v[118:119], v248 offset:17408
    ds_read_b64_tr_b16 v[40:41], v249 offset:16384
    ds_read_b64_tr_b16 v[42:43], v249 offset:17408
    v_mfma_f32_32x32x16_bf16 v[152:167], v[184:187], v[4:7], v[152:167]
    s_add_u32 s28, s28, 4096
    s_and_b32 s28, s28, 0x7fff
    buffer_load_dwordx4 v[56:59], v239, s[20:23], s28 offen offset:0 sc1
    s_waitcnt vmcnt(10) lgkmcnt(8)
    v_mfma_f32_32x32x16_bf16 v[136:151], v[108:111], v[16:19], v[136:151]
    ds_read_b64_tr_b16 v[120:121], v248 offset:20480
    ds_read_b64_tr_b16 v[122:123], v248 offset:21504
    ds_read_b64_tr_b16 v[88:89], v249 offset:20480
    ds_read_b64_tr_b16 v[90:91], v249 offset:21504
    v_mfma_f32_32x32x16_bf16 v[152:167], v[196:199], v[16:19], v[152:167]
    buffer_load_dwordx4 v[0:3], v239, s[20:23], s28 offen offset:1024 sc1
    s_waitcnt vmcnt(10) lgkmcnt(8)
    v_mfma_f32_32x32x16_bf16 v[136:151], v[112:115], v[28:31], v[136:151]
    ds_read_b64_tr_b16 v[124:125], v248 offset:24576
    ds_read_b64_tr_b16 v[126:127], v248 offset:25600
    ds_read_b64_tr_b16 v[76:77], v249 offset:24576
    ds_read_b64_tr_b16 v[78:79], v249 offset:25600
    v_mfma_f32_32x32x16_bf16 v[152:167], v[224:227], v[28:31], v[152:167]
    buffer_load_dwordx4 v[12:15], v239, s[20:23], s28 offen offset:2048 sc1
    s_lshl_b32 s30, s4, 2
    s_add_u32 s30, s30, 161008
    v_mov_b32 v240, s30
    v_mov_b32 v241, 1
    ds_write_b32 v240, v241
    s_waitcnt vmcnt(10) lgkmcnt(9)
    v_mfma_f32_32x32x16_bf16 v[136:151], v[116:119], v[36:39], v[136:151]
    ds_read_b64_tr_b16 v[128:129], v248 offset:28672
    ds_read_b64_tr_b16 v[130:131], v248 offset:29696
    ds_read_b64_tr_b16 v[80:81], v249 offset:28672
    ds_read_b64_tr_b16 v[82:83], v249 offset:29696
    v_mfma_f32_32x32x16_bf16 v[152:167], v[40:43], v[36:39], v[152:167]
    buffer_load_dwordx4 v[20:23], v239, s[20:23], s28 offen offset:3072 sc1
    s_waitcnt vmcnt(10) lgkmcnt(9)
    v_mfma_f32_32x32x16_bf16 v[136:151], v[120:123], v[48:51], v[136:151]
    ds_read_b64_tr_b16 v[132:133], v248 offset:0
    ds_read_b64_tr_b16 v[134:135], v248 offset:1024
    ds_read_b64_tr_b16 v[84:85], v249 offset:0
    ds_read_b64_tr_b16 v[86:87], v249 offset:1024
    v_mfma_f32_32x32x16_bf16 v[152:167], v[88:91], v[48:51], v[152:167]
    s_waitcnt vmcnt(8)
    s_mov_b32 s76, 0
L_p1_48:
    v_cmp_ne_u64 vcc, s[60:61], v[208:209]
    s_cbranch_vccz L_p1d_49
    global_load_dwordx2 v[208:209], v220, s[10:11] offset:2048 sc1
    s_add_u32 s76, s76, 1
    s_cmp_lt_u32 s76, 1048576
    s_waitcnt vmcnt(0)
    s_cbranch_scc1 L_p1_48
L_p1d_49:
    s_lshl_b32 s28, s73, 10
    s_add_u32 s28, s28, 32768
    buffer_load_dwordx4 v[32:35], v239, s[20:23], s28 offen offset:0 sc1
    s_waitcnt lgkmcnt(9)
    v_mfma_f32_32x32x16_bf16 v[136:151], v[124:127], v[60:63], v[136:151]
    ds_read_b64_tr_b16 v[192:193], v248 offset:4096
    ds_read_b64_tr_b16 v[194:195], v248 offset:5120
    ds_read_b64_tr_b16 v[92:93], v249 offset:4096
    ds_read_b64_tr_b16 v[94:95], v249 offset:5120
    v_mfma_f32_32x32x16_bf16 v[152:167], v[76:79], v[60:63], v[152:167]
    s_add_u32 s28, s28, 1024
    s_cmp_eq_u32 s28, 44032
    s_cselect_b32 s28, 32768, s28
    buffer_load_dwordx4 v[44:47], v239, s[20:23], s28 offen offset:0 sc1
    s_waitcnt vmcnt(9) lgkmcnt(8)
    v_mfma_f32_32x32x16_bf16 v[136:151], v[128:131], v[68:71], v[136:151]
    ds_read_b64_tr_b16 v[216:217], v248 offset:8192
    ds_read_b64_tr_b16 v[218:219], v248 offset:9216
    ds_read_b64_tr_b16 v[96:97], v249 offset:8192
    ds_read_b64_tr_b16 v[98:99], v249 offset:9216
    v_mfma_f32_32x32x16_bf16 v[152:167], v[80:83], v[68:71], v[152:167]
    s_add_u32 s28, s28, 1024
    s_cmp_eq_u32 s28, 44032
    s_cselect_b32 s28, 32768, s28
    buffer_load_dwordx4 v[52:55], v239, s[20:23], s28 offen offset:0 sc1
    s_waitcnt vmcnt(9) lgkmcnt(8)
    ds_read_b32 v233, v232
    v_mfma_f32_32x32x16_bf16 v[136:151], v[132:135], v[188:191], v[136:151]
    ds_read_b64_tr_b16 v[24:25], v248 offset:12288
    ds_read_b64_tr_b16 v[26:27], v248 offset:13312
    ds_read_b64_tr_b16 v[100:101], v249 offset:12288
    ds_read_b64_tr_b16 v[102:103], v249 offset:13312
    v_mfma_f32_32x32x16_bf16 v[152:167], v[84:87], v[188:191], v[152:167]
    s_add_u32 s28, s28, 1024
    s_cmp_eq_u32 s28, 44032
    s_cselect_b32 s28, 32768, s28
    buffer_load_dwordx4 v[64:67], v239, s[20:23], s28 offen offset:0 sc1
    s_waitcnt vmcnt(9) lgkmcnt(9)
    v_mfma_f32_32x32x16_bf16 v[136:151], v[192:195], v[212:215], v[136:151]
    s_waitcnt lgkmcnt(4)
    v_cmp_eq_u32 vcc, 0, v233
    s_lshl_b32 s30, s3, 24
    s_and_b32 s30, s30, vcc_lo
    s_cbranch_scc0 L_ck_50
    s_add_u32 s30, s77, 160864
    v_and_b32 v240, 1, v230
    v_lshlrev_b32 v240, 2, v240
    v_add_u32 v240, s30, v240
    s_mov_b32 s76, 0
L_sp_51:
    ds_read_b32 v241, v240
    s_waitcnt lgkmcnt(0)
    v_cmp_eq_u32 vcc, 0, v241
    s_cbranch_vccz L_spd_52
    s_sleep 1
    s_add_u32 s76, s76, 1
    s_cmp_lt_u32 s76, 1048576
    s_cbranch_scc1 L_sp_51
L_spd_52:
L_ck_50:
    ds_read_b64_tr_b16 v[72:73], v250 offset:0
    ds_read_b64_tr_b16 v[74:75], v250 offset:1024
    ds_read_b64_tr_b16 v[104:105], v251 offset:0
    ds_read_b64_tr_b16 v[106:107], v251 offset:1024
    v_mfma_f32_32x32x16_bf16 v[152:167], v[92:95], v[212:215], v[152:167]
    s_add_u32 s28, s28, 1024
    s_cmp_eq_u32 s28, 44032
    s_cselect_b32 s28, 32768, s28
    buffer_load_dwordx4 v[184:187], v239, s[20:23], s28 offen offset:0 sc1
    s_waitcnt vmcnt(9)
    v_mfma_f32_32x32x16_bf16 v[136:151], v[216:219], v[8:11], v[136:151]
    ds_read_b64_tr_b16 v[4:5], v250 offset:4096
    ds_read_b64_tr_b16 v[6:7], v250 offset:5120
    ds_read_b64_tr_b16 v[108:109], v251 offset:4096
    ds_read_b64_tr_b16 v[110:111], v251 offset:5120
    v_mfma_f32_32x32x16_bf16 v[152:167], v[96:99], v[8:11], v[152:167]
    s_add_u32 s28, s28, 1024
    s_cmp_eq_u32 s28, 44032
    s_cselect_b32 s28, 32768, s28
    buffer_load_dwordx4 v[196:199], v239, s[20:23], s28 offen offset:0 sc1
    v_mov_b32 v240, 160920
    v_mov_b32 v241, 1
    ds_write_b32 v240, v241
    s_waitcnt vmcnt(9) lgkmcnt(9)
    v_mfma_f32_32x32x16_bf16 v[136:151], v[24:27], v[56:59], v[136:151]
    ds_read_b64_tr_b16 v[16:17], v250 offset:8192
    ds_read_b64_tr_b16 v[18:19], v250 offset:9216
    ds_read_b64_tr_b16 v[112:113], v251 offset:8192
    ds_read_b64_tr_b16 v[114:115], v251 offset:9216
    v_mfma_f32_32x32x16_bf16 v[152:167], v[100:103], v[56:59], v[152:167]
    s_add_u32 s28, s28, 1024
    s_cmp_eq_u32 s28, 44032
    s_cselect_b32 s28, 32768, s28
    buffer_load_dwordx4 v[224:227], v239, s[20:23], s28 offen offset:0 sc1
    s_waitcnt vmcnt(9) lgkmcnt(9)
    v_mfma_f32_32x32x16_bf16 v[136:151], v[72:75], v[0:3], v[136:151]
    ds_read_b64_tr_b16 v[28:29], v250 offset:32768
    ds_read_b64_tr_b16 v[30:31], v250 offset:33792
    ds_read_b64_tr_b16 v[116:117], v251 offset:32768
    ds_read_b64_tr_b16 v[118:119], v251 offset:33792
    v_mfma_f32_32x32x16_bf16 v[152:167], v[104:107], v[0:3], v[152:167]
    s_add_u32 s28, s28, 1024
    s_cmp_eq_u32 s28, 44032
    s_cselect_b32 s28, 32768, s28
    buffer_load_dwordx4 v[40:43], v239, s[20:23], s28 offen offset:0 sc1
    s_waitcnt vmcnt(9) lgkmcnt(9)
    v_mfma_f32_32x32x16_bf16 v[136:151], v[4:7], v[12:15], v[136:151]
    ds_read_b64_tr_b16 v[36:37], v250 offset:36864
    ds_read_b64_tr_b16 v[38:39], v250 offset:37888
    ds_read_b64_tr_b16 v[120:121], v251 offset:36864
    ds_read_b64_tr_b16 v[122:123], v251 offset:37888
    v_mfma_f32_32x32x16_bf16 v[152:167], v[108:111], v[12:15], v[152:167]
    s_add_u32 s28, s28, 1024
    s_cmp_eq_u32 s28, 44032
    s_cselect_b32 s28, 32768, s28
    buffer_load_dwordx4 v[88:91], v239, s[20:23], s28 offen offset:0 sc1
    s_waitcnt vmcnt(9) lgkmcnt(8)
    v_mfma_f32_32x32x16_bf16 v[136:151], v[16:19], v[20:23], v[136:151]
    ds_read_b64_tr_b16 v[48:49], v250 offset:40960
    ds_read_b64_tr_b16 v[50:51], v250 offset:41984
    ds_read_b64_tr_b16 v[124:125], v251 offset:40960
    ds_read_b64_tr_b16 v[126:127], v251 offset:41984
    v_mfma_f32_32x32x16_bf16 v[152:167], v[112:115], v[20:23], v[152:167]
    s_add_u32 s28, s28, 1024
    s_cmp_eq_u32 s28, 44032
    s_cselect_b32 s28, 32768, s28
    buffer_load_dwordx4 v[76:79], v239, s[20:23], s28 offen offset:0 sc1
    s_waitcnt vmcnt(9) lgkmcnt(8)
    v_mfma_f32_32x32x16_bf16 v[136:151], v[28:31], v[32:35], v[136:151]
    ds_read_b64_tr_b16 v[60:61], v250 offset:12288
    ds_read_b64_tr_b16 v[62:63], v250 offset:13312
    ds_read_b64_tr_b16 v[128:129], v251 offset:12288
    ds_read_b64_tr_b16 v[130:131], v251 offset:13312
    v_mfma_f32_32x32x16_bf16 v[152:167], v[116:119], v[32:35], v[152:167]
    s_add_u32 s28, s28, 1024
    s_cmp_eq_u32 s28, 44032
    s_cselect_b32 s28, 32768, s28
    buffer_load_dwordx4 v[80:83], v239, s[20:23], s28 offen offset:0 sc1
    buffer_load_dwordx4 v[200:203], v221, s[12:15], s27 offen offset:0
    buffer_load_dwordx4 v[204:207], v221, s[12:15], s27 offen offset:16
    s_waitcnt vmcnt(11) lgkmcnt(8)
    v_mfma_f32_32x32x16_bf16 v[136:151], v[36:39], v[44:47], v[136:151]
    ds_read_b64_tr_b16 v[68:69], v250 offset:16384
    ds_read_b64_tr_b16 v[70:71], v250 offset:17408
    ds_read_b64_tr_b16 v[132:133], v251 offset:16384
    ds_read_b64_tr_b16 v[134:135], v251 offset:17408
    v_mfma_f32_32x32x16_bf16 v[152:167], v[120:123], v[44:47], v[152:167]
    s_waitcnt vmcnt(10) lgkmcnt(8)
    v_mfma_f32_32x32x16_bf16 v[136:151], v[48:51], v[52:55], v[136:151]
    ds_read_b64_tr_b16 v[84:85], v250 offset:20480
    ds_read_b64_tr_b16 v[86:87], v250 offset:21504
    ds_read_b64_tr_b16 v[188:189], v251 offset:20480
    ds_read_b64_tr_b16 v[190:191], v251 offset:21504
    v_mfma_f32_32x32x16_bf16 v[152:167], v[124:127], v[52:55], v[152:167]
    s_waitcnt vmcnt(9) lgkmcnt(8)
    ds_read_b32 v233, v232
    v_mfma_f32_32x32x16_bf16 v[136:151], v[60:63], v[64:67], v[136:151]
    ds_read_b64_tr_b16 v[192:193], v250 offset:24576
    ds_read_b64_tr_b16 v[194:195], v250 offset:25600
    ds_read_b64_tr_b16 v[92:93], v251 offset:24576
    ds_read_b64_tr_b16 v[94:95], v251 offset:25600
    v_mfma_f32_32x32x16_bf16 v[152:167], v[128:131], v[64:67], v[152:167]
    s_waitcnt vmcnt(8) lgkmcnt(9)
    ds_read_b32 v233, v232
    v_mfma_f32_32x32x16_bf16 v[136:151], v[68:71], v[184:187], v[136:151]
    s_waitcnt lgkmcnt(0)
    v_cmp_eq_u32 vcc, 0, v233
    s_lshl_b32 s30, s3, 16
    s_and_b32 s30, s30, vcc_hi
    s_cbranch_scc0 L_ck_53
    s_add_u32 s30, s77, 160960
    v_and_b32 v240, 1, v230
    v_lshlrev_b32 v240, 2, v240
    v_add_u32 v240, s30, v240
    s_mov_b32 s76, 0
L_sp_54:
    ds_read_b32 v241, v240
    s_waitcnt lgkmcnt(0)
    v_cmp_eq_u32 vcc, 0, v241
    s_cbranch_vccz L_spd_55
    s_sleep 1
    s_add_u32 s76, s76, 1
    s_cmp_lt_u32 s76, 1048576
    s_cbranch_scc1 L_sp_54
L_spd_55:
L_ck_53:
    v_cmp_eq_u32 vcc, 0, v233
    s_lshl_b32 s30, s3, 28
    s_and_b32 s30, s30, vcc_hi
    s_cbranch_scc0 L_ck_56
    s_add_u32 s30, s77, 161008
    v_and_b32 v240, 1, v230
    v_lshlrev_b32 v240, 2, v240
    v_add_u32 v240, s30, v240
    s_mov_b32 s76, 0
L_sp_57:
    ds_read_b32 v241, v240
    s_waitcnt lgkmcnt(0)
    v_cmp_eq_u32 vcc, 0, v241
    s_cbranch_vccz L_spd_58
    s_sleep 1
    s_add_u32 s76, s76, 1
    s_cmp_lt_u32 s76, 1048576
    s_cbranch_scc1 L_sp_57
L_spd_58:
L_ck_56:
    ds_read_b64_tr_b16 v[212:213], v248 offset:32768
    ds_read_b64_tr_b16 v[214:215], v248 offset:33792
    ds_read_b64_tr_b16 v[216:217], v249 offset:32768
    ds_read_b64_tr_b16 v[218:219], v249 offset:33792
    v_mfma_f32_32x32x16_bf16 v[152:167], v[132:135], v[184:187], v[152:167]
    s_waitcnt vmcnt(7)
    v_mfma_f32_32x32x16_bf16 v[136:151], v[84:87], v[196:199], v[136:151]
    ds_read_b64_tr_b16 v[96:97], v248 offset:36864
    ds_read_b64_tr_b16 v[98:99], v248 offset:37888
    ds_read_b64_tr_b16 v[8:9], v249 offset:36864
    ds_read_b64_tr_b16 v[10:11], v249 offset:37888
    v_mfma_f32_32x32x16_bf16 v[152:167], v[188:191], v[196:199], v[152:167]
    v_cmp_eq_u32 vcc, 0, v233
    s_nop 0
    s_and_b32 s30, 0x8, vcc_lo
    s_cbranch_scc0 L_ck_59
    v_and_b32 v240, 0, v230
    v_lshlrev_b32 v240, 2, v240
    v_add_u32 v240, 160780, v240
    s_mov_b32 s76, 0
L_sp_60:
    ds_read_b32 v241, v240
    s_waitcnt lgkmcnt(0)
    v_cmp_eq_u32 vcc, 0, v241
    s_cbranch_vccz L_spd_61
    s_sleep 1
    s_add_u32 s76, s76, 1
    s_cmp_lt_u32 s76, 1048576
    s_cbranch_scc1 L_sp_60
L_spd_61:
L_ck_59:
    s_add_u32 s30, s74, 0
    buffer_load_dwordx4 v[184:187], v254, s[16:19], s30 offen sc1
    s_add_u32 s30, s74, 4096
    buffer_load_dwordx4 v[132:135], v254, s[16:19], s30 offen sc1
    s_waitcnt vmcnt(8)
    ds_read_b64_tr_b16 v[24:25], v248 offset:40960
    ds_read_b64_tr_b16 v[26:27], v248 offset:41984
    ds_read_b64_tr_b16 v[100:101], v249 offset:40960
    ds_read_b64_tr_b16 v[102:103], v249 offset:41984
    v_mfma_f32_32x32x16_bf16 v[152:167], v[92:95], v[224:227], v[152:167]
    s_add_u32 s30, s74, 8192
    buffer_load_dwordx4 v[128:131], v254, s[16:19], s30 offen sc1
    s_add_u32 s30, s74, 12288
    buffer_load_dwordx4 v[124:127], v254, s[16:19], s30 offen sc1
    s_waitcnt vmcnt(9) lgkmcnt(8)
    ds_read_b32 v233, v232
    ds_read_b64_tr_b16 v[56:57], v248 offset:45056
    ds_read_b64_tr_b16 v[58:59], v248 offset:46080
    ds_read_b64_tr_b16 v[72:73], v249 offset:45056
    ds_read_b64_tr_b16 v[74:75], v249 offset:46080
    v_mfma_f32_32x32x16_bf16 v[152:167], v[216:219], v[40:43], v[152:167]
    s_add_u32 s30, s74, 16384
    buffer_load_dwordx4 v[188:191], v254, s[16:19], s30 offen sc1
    s_add_u32 s30, s74, 20480
    buffer_load_dwordx4 v[120:123], v254, s[16:19], s30 offen sc1
    s_waitcnt vmcnt(10) lgkmcnt(9)
    v_mfma_f32_32x32x16_bf16 v[152:167], v[8:11], v[88:91], v[152:167]
    s_add_u32 s30, s74, 24576
    buffer_load_dwordx4 v[196:199], v254, s[16:19], s30 offen sc1
    s_add_u32 s30, s74, 28672
    buffer_load_dwordx4 v[116:119], v254, s[16:19], s30 offen sc1
    s_waitcnt lgkmcnt(4)
    v_cmp_eq_u32 vcc, 0, v233
    s_nop 0
    s_and_b32 s30, 0xf00000, vcc_hi
    s_cbranch_scc0 L_ck_62
    v_and_b32 v240, 3, v230
    v_lshlrev_b32 v240, 2, v240
    v_add_u32 v240, 160976, v240
    s_mov_b32 s76, 0
L_sp_63:
    ds_read_b32 v241, v240
    s_waitcnt lgkmcnt(0)
    v_cmp_eq_u32 vcc, 0, v241
    s_cbranch_vccz L_spd_64
    s_sleep 1
    s_add_u32 s76, s76, 1
    s_cmp_lt_u32 s76, 1048576
    s_cbranch_scc1 L_sp_63
L_spd_64:
L_ck_62:
    ds_read_b128 v[112:115], v255 offset:0
    ds_read_b128 v[108:111], v255 offset:1024
    ds_read_b128 v[104:107], v255 offset:2048
    ds_read_b128 v[84:87], v255 offset:3072
    ds_read_b128 v[68:71], v255 offset:4096
    ds_read_b128 v[64:67], v255 offset:5120
    ds_read_b128 v[60:63], v255 offset:6144
    ds_read_b128 v[52:55], v255 offset:7168
    s_waitcnt vmcnt(11)
    v_mfma_f32_32x32x16_bf16 v[152:167], v[100:103], v[76:79], v[152:167]
    s_waitcnt vmcnt(10) lgkmcnt(8)
    v_mfma_f32_32x32x16_bf16 v[152:167], v[72:75], v[80:83], v[152:167]
    s_waitcnt vmcnt(8)
    v_mfma_f32_32x32x16_bf16 v[136:151], v[192:195], v[224:227], v[136:151]
    v_lshlrev_b32 v0, 16, v200
    v_and_b32 v1, s32, v200
    v_lshlrev_b32 v2, 16, v201
    v_and_b32 v3, s32, v201
    v_lshlrev_b32 v4, 16, v202
    v_and_b32 v5, s32, v202
    v_mfma_f32_32x32x16_bf16 v[136:151], v[212:215], v[40:43], v[136:151]
    v_lshlrev_b32 v6, 16, v203
    v_and_b32 v7, s32, v203
    v_lshlrev_b32 v8, 16, v204
    v_and_b32 v9, s32, v204
    v_lshlrev_b32 v10, 16, v205
    v_and_b32 v11, s32, v205
    ds_write_b128 v210, v[152:155] offset:0
    ds_write_b128 v210, v[156:159] offset:1024
    v_mfma_f32_32x32x16_bf16 v[136:151], v[96:99], v[88:91], v[136:151]
    ds_write_b128 v210, v[160:163] offset:4096
    ds_write_b128 v210, v[164:167] offset:5120
    ds_write_b32 v228, v228
    v_mfma_f32_32x32x16_bf16 v[136:151], v[24:27], v[76:79], v[136:151]
    v_lshlrev_b32 v12, 16, v206
    v_and_b32 v13, s32, v206
    v_lshlrev_b32 v14, 16, v207
    v_mfma_f32_32x32x16_bf16 v[136:151], v[56:59], v[80:83], v[136:151]
    v_and_b32 v15, s32, v207
    v_mov_b32 v252, 0xbfb8aa3b
    s_mov_b32 s76, 0
L_ps_65:
    ds_read_b32 v240, v229
    s_add_u32 s76, s76, 1
    s_waitcnt lgkmcnt(0)
    v_cmp_eq_u32 vcc, 0, v240
    s_cbranch_vccz L_psd_66
    s_cmp_lt_u32 s76, 2097152
    s_cbranch_scc1 L_ps_65
L_psd_66:
    ds_read_b128 v[152:155], v211 offset:0
    ds_read_b128 v[156:159], v211 offset:1024
    ds_read_b128 v[160:163], v211 offset:4096
    ds_read_b128 v[164:167], v211 offset:5120
    s_nop 1
    s_waitcnt lgkmcnt(3)
    v_pk_add_f32 v[136:137], v[136:137], v[152:153]
    v_pk_add_f32 v[138:139], v[138:139], v[154:155]
    s_waitcnt lgkmcnt(2)
    v_pk_add_f32 v[140:141], v[140:141], v[156:157]
    v_pk_add_f32 v[142:143], v[142:143], v[158:159]
    s_waitcnt lgkmcnt(1)
    v_pk_add_f32 v[144:145], v[144:145], v[160:161]
    v_pk_add_f32 v[146:147], v[146:147], v[162:163]
    s_waitcnt lgkmcnt(0)
    v_pk_add_f32 v[148:149], v[148:149], v[164:165]
    v_pk_add_f32 v[150:151], v[150:151], v[166:167]
    v_pk_mul_f32 v[16:17], v[136:137], v[252:253] op_sel_hi:[1,0]
    v_pk_mul_f32 v[18:19], v[138:139], v[252:253] op_sel_hi:[1,0]
    v_pk_mul_f32 v[20:21], v[140:141], v[252:253] op_sel_hi:[1,0]
    v_pk_mul_f32 v[22:23], v[142:143], v[252:253] op_sel_hi:[1,0]
    v_pk_mul_f32 v[24:25], v[144:145], v[252:253] op_sel_hi:[1,0]
    v_pk_mul_f32 v[26:27], v[146:147], v[252:253] op_sel_hi:[1,0]
    v_pk_mul_f32 v[28:29], v[148:149], v[252:253] op_sel_hi:[1,0]
    v_pk_mul_f32 v[30:31], v[150:151], v[252:253] op_sel_hi:[1,0]
    s_waitcnt vmcnt(7)
    v_mfma_f32_32x32x16_bf16 v[168:183], v[184:187], v[112:115], 0
    v_exp_f32 v16, v16
    v_exp_f32 v17, v17
    v_exp_f32 v18, v18
    v_exp_f32 v19, v19
    s_waitcnt vmcnt(6)
    v_mfma_f32_32x32x16_bf16 v[168:183], v[132:135], v[108:111], v[168:183]
    v_exp_f32 v20, v20
    v_exp_f32 v21, v21
    v_exp_f32 v22, v22
    v_exp_f32 v23, v23
    s_waitcnt vmcnt(5)
    v_mfma_f32_32x32x16_bf16 v[168:183], v[128:131], v[104:107], v[168:183]
    v_exp_f32 v24, v24
    v_exp_f32 v25, v25
    v_exp_f32 v26, v26
    v_exp_f32 v27, v27
    s_waitcnt vmcnt(4)
    v_mfma_f32_32x32x16_bf16 v[168:183], v[124:127], v[84:87], v[168:183]
    v_exp_f32 v28, v28
    v_exp_f32 v29, v29
    v_exp_f32 v30, v30
    v_exp_f32 v31, v31
    s_nop 0
    v_add_f32 v16, 1.0, v16
    s_waitcnt vmcnt(3)
    v_mfma_f32_32x32x16_bf16 v[168:183], v[188:191], v[68:71], v[168:183]
    v_add_f32 v17, 1.0, v17
    v_add_f32 v18, 1.0, v18
    v_add_f32 v19, 1.0, v19
    v_add_f32 v20, 1.0, v20
    v_add_f32 v21, 1.0, v21
    v_add_f32 v22, 1.0, v22
    v_add_f32 v23, 1.0, v23
    v_add_f32 v24, 1.0, v24
    s_waitcnt vmcnt(2)
    v_mfma_f32_32x32x16_bf16 v[168:183], v[120:123], v[64:67], v[168:183]
    v_add_f32 v25, 1.0, v25
    v_add_f32 v26, 1.0, v26
    v_add_f32 v27, 1.0, v27
    v_add_f32 v28, 1.0, v28
    v_add_f32 v29, 1.0, v29
    v_add_f32 v30, 1.0, v30
    v_add_f32 v31, 1.0, v31
    s_waitcnt vmcnt(1)
    v_mfma_f32_32x32x16_bf16 v[168:183], v[196:199], v[60:63], v[168:183]
    v_rcp_f32 v16, v16
    v_rcp_f32 v17, v17
    v_rcp_f32 v18, v18
    s_waitcnt vmcnt(0)
    v_mfma_f32_32x32x16_bf16 v[168:183], v[116:119], v[52:55], v[168:183]
    v_rcp_f32 v19, v19
    v_rcp_f32 v20, v20
    v_rcp_f32 v21, v21
    v_rcp_f32 v22, v22
    v_rcp_f32 v23, v23
    v_rcp_f32 v24, v24
    v_rcp_f32 v25, v25
    v_rcp_f32 v26, v26
    v_rcp_f32 v27, v27
    v_rcp_f32 v28, v28
    v_rcp_f32 v29, v29
    v_rcp_f32 v30, v30
    v_rcp_f32 v31, v31
    s_nop 0
    v_pk_mul_f32 v[136:137], v[136:137], v[16:17]
    v_pk_mul_f32 v[138:139], v[138:139], v[18:19]
    v_pk_mul_f32 v[140:141], v[140:141], v[20:21]
    v_pk_mul_f32 v[142:143], v[142:143], v[22:23]
    v_pk_mul_f32 v[144:145], v[144:145], v[24:25]
    v_pk_mul_f32 v[146:147], v[146:147], v[26:27]
    v_pk_mul_f32 v[148:149], v[148:149], v[28:29]
    v_pk_mul_f32 v[150:151], v[150:151], v[30:31]
    v_pk_fma_f32 v[0:1], v[136:137], v[168:169], v[0:1]
    v_pk_fma_f32 v[2:3], v[138:139], v[170:171], v[2:3]
    v_pk_fma_f32 v[4:5], v[140:141], v[172:173], v[4:5]
    v_pk_fma_f32 v[6:7], v[142:143], v[174:175], v[6:7]
    v_pk_fma_f32 v[8:9], v[144:145], v[176:177], v[8:9]
    v_pk_fma_f32 v[10:11], v[146:147], v[178:179], v[10:11]
    v_pk_fma_f32 v[12:13], v[148:149], v[180:181], v[12:13]
    v_pk_fma_f32 v[14:15], v[150:151], v[182:183], v[14:15]
    v_cvt_pk_bf16_f32 v152, v0, v1
    v_cvt_pk_bf16_f32 v153, v2, v3
    v_cvt_pk_bf16_f32 v154, v4, v5
    v_cvt_pk_bf16_f32 v155, v6, v7
    v_cvt_pk_bf16_f32 v156, v8, v9
    v_cvt_pk_bf16_f32 v157, v10, v11
    v_cvt_pk_bf16_f32 v158, v12, v13
    v_cvt_pk_bf16_f32 v159, v14, v15
    ds_write_b128 v236, v[152:155] offset:0
    ds_write_b128 v236, v[156:159] offset:16
    ds_read_b128 v[160:163], v237 offset:0
    ds_read_b128 v[164:167], v237 offset:2304
    s_waitcnt lgkmcnt(0)
    buffer_store_dwordx4 v[160:163], v238, s[68:71], s33 offen sc1
    buffer_store_dwordx4 v[164:167], v238, s[68:71], s34 offen sc1
    s_endpgm
K_end:
PF_end:
    s_endpgm
.section .rodata,"a"
.p2align 6
.amdhsa_kernel recurrent_scan__spectral_fnet__glu_gated_geglu__prompt_kernel
  .amdhsa_next_free_vgpr 256
  .amdhsa_next_free_sgpr 102
  .amdhsa_accum_offset 256
  .amdhsa_group_segment_fixed_size 0
  .amdhsa_kernarg_size 96
  .amdhsa_user_sgpr_count 2
  .amdhsa_user_sgpr_kernarg_segment_ptr 1
  .amdhsa_system_sgpr_workgroup_id_x 1
.end_amdhsa_kernel
```
